```python
import torch

def _softmax(x, axis=-1):
    return torch.softmax(x, dim=axis)
def _gelu(x):
    return torch.nn.functional.gelu(x, approximate="tanh")
def _silu(x):
    return torch.nn.functional.silu(x)
def _sigmoid(x):
    return torch.sigmoid(x)
def _layernorm(x, axis=-1, eps=1e-5):
    m = x.mean(dim=axis, keepdim=True)
    v = x.var(dim=axis, keepdim=True, unbiased=False)
    return (x - m) / torch.sqrt(v + eps)
def _scatter_add(tgt, idx, src, axis=0):
    return tgt.clone().index_add_(axis, idx, src)
def _segment_sum(src, seg, n):
    out = torch.zeros((n,) + src.shape[1:], dtype=src.dtype)
    return out.index_add_(0, seg, src)
def _pad(x, pw):
    flat = tuple(v for pair in reversed(pw) for v in pair)
    return torch.nn.functional.pad(x, flat)

kernel_name = 'sequential_preLN__gqa_block_cached__glu_gated_geglu__decode'

def setup_inputs():

    _w = (lambda a: (lambda t: t.to(torch.bfloat16) if t.is_floating_point() else t)(torch.as_tensor(a)))
    def _A_setup():
        B, Sq, D = 1, 1, 1024
        Hq, Hkv, Sk, Dh = 32, 4, 65536, 128
        assert Hq % Hkv == 0, (Hq, Hkv)
        return {
            "x": _w((lambda *s: torch.randn(*s, dtype=torch.bfloat16) * 0.05)(B, Sq, D)),
            "k_cache": _w((lambda *s: torch.randn(*s, dtype=torch.bfloat16) * 3.2)(B, Hkv, Sk, Dh)),
            "v_cache": _w((lambda *s: torch.randn(*s, dtype=torch.bfloat16) * 1.6)(B, Hkv, Sk, Dh)),
            "wq": _w((lambda *s: torch.randn(*s, dtype=torch.bfloat16) * 3.2)(D, Hq * Dh) * (D ** -0.5)),
            "wo": _w((lambda *s: torch.randn(*s, dtype=torch.bfloat16) * 1.6)(Hq * Dh, D) * ((Hq * Dh) ** -0.5)),
        }
    _A_in = _A_setup()

    def _B_setup():
        B, S, Dm, Df = 1, 1, 1024, 3584
        return {
            "x": _w((lambda *s: torch.randn(*s, dtype=torch.bfloat16) * 0.05)(B, S, Dm)),
            "w_gate": _w((lambda *s: torch.randn(*s, dtype=torch.bfloat16) * 1.6)(Dm, Df) * (Dm ** -0.5)),
            "w_up": _w((lambda *s: torch.randn(*s, dtype=torch.bfloat16) * 1.6)(Dm, Df) * (Dm ** -0.5)),
            "w_down": _w((lambda *s: torch.randn(*s, dtype=torch.bfloat16) * 1.6)(Df, Dm) * (Df ** -0.5)),
        }
    _B_in = _B_setup()

    return {
        "A_x": _A_in["x"],
        "A_k_cache": _A_in["k_cache"],
        "A_v_cache": _A_in["v_cache"],
        "A_wq": _A_in["wq"],
        "A_wo": _A_in["wo"],
        "B_x": _B_in["x"],
        "B_w_gate": _B_in["w_gate"],
        "B_w_up": _B_in["w_up"],
        "B_w_down": _B_in["w_down"],
    }

def reference(A_x, A_k_cache, A_v_cache, A_wq, A_wo, B_x, B_w_gate, B_w_up, B_w_down):
    def _A_ref(x, k_cache, v_cache, wq, wo):
        B, Sq, D = x.shape
        Hq, Dh = 32, 128
        Hkv = k_cache.shape[1]
        rep = Hq // Hkv
        q = (lambda x, *d: x.permute(*d))((x @ wq).reshape(B, Sq, Hq, Dh), 0, 2, 1, 3)
        k = (lambda x, n, axis: torch.repeat_interleave(x, n, dim=axis))(k_cache, rep, axis=1)
        v = (lambda x, n, axis: torch.repeat_interleave(x, n, dim=axis))(v_cache, rep, axis=1)
        scores = torch.einsum("bhqd,bhkd->bhqk", q, k) * (Dh ** -0.5)
        p = _softmax(scores, axis=-1)
        o = torch.einsum("bhqk,bhkd->bhqd", p, v)
        return (lambda x, *d: x.permute(*d))(o, 0, 2, 1, 3).reshape(B, Sq, Hq * Dh) @ wo

    def _B_ref(x, w_gate, w_up, w_down):
        g = torch.einsum("bsd,df->bsf", x, w_gate)
        u = torch.einsum("bsd,df->bsf", x, w_up)
        h = _gelu(g) * u
        return torch.einsum("bsf,fd->bsd", h, w_down)

    x = A_x
    h = x + _A_ref(_layernorm(x, axis=-1), A_k_cache, A_v_cache, A_wq, A_wo)
    h2 = h + _B_ref(_layernorm(h, axis=-1), B_w_gate, B_w_up, B_w_down)
    return h2
```

```asm
; @launch grid=(256,1,1) block=(512,1,1) lds=138048
.amdgcn_target "amdgcn-amd-amdhsa--gfx950"
.text
.globl sequential_preLN__gqa_block_cached__glu_gated_geglu__decode_kernel
.p2align 8
.type sequential_preLN__gqa_block_cached__glu_gated_geglu__decode_kernel,@function
sequential_preLN__gqa_block_cached__glu_gated_geglu__decode_kernel:
    s_cmp_ge_u32 s2, 256
    s_cbranch_scc1 L_end
    s_load_dwordx2 s[32:33], s[0:1], 0
    s_load_dwordx2 s[12:13], s[0:1], 24
    s_load_dwordx2 s[4:5], s[0:1], 8
    s_load_dwordx2 s[36:37], s[0:1], 88
    s_load_dwordx2 s[8:9], s[0:1], 16
    s_load_dwordx2 s[16:17], s[0:1], 32
    s_load_dwordx2 s[20:21], s[0:1], 48
    s_load_dwordx2 s[24:25], s[0:1], 56
    s_load_dwordx2 s[28:29], s[0:1], 64
    s_load_dwordx2 s[40:41], s[0:1], 72
    s_load_dwordx2 s[44:45], s[0:1], 80
    v_and_b32 v1, 63, v0
    v_lshrrev_b32 v9, 6, v0
    v_lshrrev_b32 v2, 4, v1
    v_and_b32 v3, 15, v1
    v_readfirstlane_b32 s3, v9
    v_lshrrev_b32 v9, 3, v1
    v_and_b32 v10, 7, v1
    v_lshlrev_b32 v10, 4, v10
    v_lshl_add_u32 v7, v9, 13, v10
    v_mul_u32_u24 v8, 7168, v9
    v_add_u32 v8, v8, v10
    v_lshlrev_b32 v9, 5, v1
    v_lshlrev_b32 v10, 3, v1
    s_bfe_u32 s60, s2, 0x20003
    s_lshl_b32 s61, s3, 12
    s_lshl_b32 s49, s60, 8
    s_lshl_b32 s63, s3, 5
    s_add_u32 s49, s49, s63
    s_and_b32 s88, s2, 7
    s_lshr_b32 s89, s2, 5
    s_sub_u32 s63, s88, s89
    s_and_b32 s63, s63, 7
    s_lshl_b32 s84, s89, 3
    s_add_u32 s84, s84, s63
    s_lshl_b32 s50, s49, 13
    s_lshl_b32 s62, s84, 7
    s_add_u32 s50, s50, s62
    s_mul_i32 s51, s49, 7168
    s_lshl_b32 s63, s60, 9
    s_cmp_eq_u32 s3, 0
    s_cselect_b32 s62, 0, 0x1000
    s_add_u32 s63, s63, s62
    s_mov_b32 s34, 2048
    s_mov_b32 s35, 0x20000
    s_mov_b32 s14, 8388608
    s_mov_b32 s15, 0x20000
    s_waitcnt lgkmcnt(0)
    buffer_load_dwordx4 v[32:35], v9, s[32:35], s62 offen
    buffer_load_dwordx4 v[36:39], v9, s[32:35], s62 offen offset:16
    buffer_load_dwordx2 v[40:41], v10, s[32:35], s63 offen
    s_add_u32 s49, s50, 0
    s_add_u32 m0, s61, 0
    s_nop 0
    buffer_load_dwordx4 v7, s[12:15], s49 offen nt lds
    s_add_u32 s49, s50, 65536
    s_add_u32 m0, s61, 1024
    s_nop 0
    buffer_load_dwordx4 v7, s[12:15], s49 offen nt lds
    s_add_u32 s49, s50, 131072
    s_add_u32 m0, s61, 2048
    s_nop 0
    buffer_load_dwordx4 v7, s[12:15], s49 offen nt lds
    s_add_u32 s49, s50, 196608
    s_add_u32 m0, s61, 3072
    s_nop 0
    buffer_load_dwordx4 v7, s[12:15], s49 offen nt lds
    s_load_dword s87, s[36:37], 163840
    s_getpc_b64 s[52:53]
L_pc0:
    s_mov_b32 s54, L_end-L_pc0
    s_mov_b32 s55, 0x20000
    v_lshlrev_b32 v42, 7, v0
    buffer_load_dword v43, v42, s[52:55], 0 offen
    s_mov_b32 s6, 67108864
    s_mov_b32 s7, 0x20000
    s_mov_b32 s38, 2097152
    s_mov_b32 s39, 0x20000
    s_lshr_b32 s58, s2, 6
    s_and_b32 s59, s2, 63
    v_and_b32 v9, 3, v3
    v_lshlrev_b32 v5, 10, v9
    v_bfe_u32 v9, v3, 2, 1
    v_lshl_add_u32 v5, v9, 8, v5
    v_lshrrev_b32 v9, 3, v3
    v_lshl_add_u32 v5, v9, 6, v5
    v_lshl_add_u32 v5, v2, 4, v5
    s_lshl_b32 s48, s2, 18
    s_mul_i32 s49, s3, 4096
    s_add_u32 s48, s48, s49
    s_barrier
    s_add_u32 s96, s48, 0
    buffer_load_dwordx4 v[128:131], v5, s[4:7], s96 offen offset:0 nt
    buffer_load_dwordx4 v[132:135], v5, s[4:7], s96 offen offset:128 nt
    s_mov_b32 s10, 67108864
    s_mov_b32 s11, 0x20000
    s_mov_b32 s18, 8388608
    s_mov_b32 s19, 0x20000
    s_mov_b32 s22, 7340032
    s_mov_b32 s23, 0x20000
    s_mov_b32 s26, 7340032
    s_mov_b32 s27, 0x20000
    s_mov_b32 s30, 7340032
    s_mov_b32 s31, 0x20000
    s_mov_b32 s42, 2048
    s_mov_b32 s43, 0x20000
    s_mov_b32 s46, 256
    s_mov_b32 s47, 0x20000
    v_lshrrev_b32 v4, 5, v1
    v_lshlrev_b32 v4, 11, v4
    v_and_b32 v11, 31, v1
    v_lshl_add_u32 v4, v11, 4, v4
    v_lshlrev_b32 v6, 4, v1
    v_lshrrev_b32 v7, 5, v1
    v_lshlrev_b32 v7, 14, v7
    v_and_b32 v11, 31, v1
    v_lshl_add_u32 v7, v11, 4, v7
    s_mul_i32 s90, s88, 7
    s_add_u32 s93, s90, s89
    s_mov_b32 s85, s90
    s_mov_b32 s100, s89
    s_lshl_b32 s62, s60, 9
    s_lshl_b32 s52, s93, 17
    s_lshl_b32 s63, s3, 14
    s_add_u32 s52, s52, s63
    s_add_u32 s52, s52, s62
    s_cmp_ge_u32 s2, 224
    s_cselect_b32 s51, 0x70000000, s51
    s_cselect_b32 s52, 0x70000000, s52
    s_and_b32 s90, s89, 1
    s_lshl_b32 s91, s88, 1
    s_add_u32 s90, s90, s91
    s_lshl_b32 s54, s90, 8
    s_lshl_b32 s53, s58, 10
    s_lshr_b32 s91, s90, 2
    s_add_u32 s53, s53, s91
    s_and_b32 s91, s90, 3
    s_lshl_b32 s91, s91, 5
    s_add_u32 s53, s53, s91
    s_and_b32 s91, s3, 3
    s_lshl_b32 s91, s91, 8
    s_add_u32 s53, s53, s91
    s_and_b32 s91, s3, 4
    s_add_u32 s53, s53, s91
    s_lshl_b32 s53, s53, 11
    s_add_u32 s53, s53, s62
    s_lshl_b32 s62, s60, 10
    s_lshl_b32 s63, s3, 7
    s_add_u32 s62, s62, s63
    s_add_u32 s62, s62, 1245184
    s_lshl_b32 s92, s58, 4
    s_add_u32 s92, s92, s90
    s_lshl_b32 s92, s92, 12
    s_add_u32 s92, s92, s62
    s_lshl_b32 s95, s93, 12
    s_add_u32 s95, s95, s62
    s_mov_b32 s55, 0x05040100
    s_mov_b32 s56, 0x07060302
    s_mov_b32 s57, 0x3f803f80
    s_mov_b32 s94, 0xffff0000
    s_mul_i32 s99, s3, 4224
    s_mov_b32 s98, 1069066811
    v_mov_b32 v44, -1
    v_mov_b32 v45, -1
    v_mov_b32 v46, -1
    v_mov_b32 v47, -1
    v_mov_b32 v12, 2147483632
    v_lshlrev_b32 v48, 4, v0
    v_cmp_gt_u32 vcc, 448, v0
    s_nop 1
    v_cndmask_b32 v48, v12, v48, vcc
    s_mul_i32 s101, s2, 7168
    s_add_u32 s101, s101, 196608
    s_and_b32 s63, s3, 3
    s_lshl_b32 s63, s63, 5
    s_add_u32 s63, s63, 0
    v_lshrrev_b32 v9, 2, v3
    v_lshl_add_u32 v9, v2, 3, v9
    v_lshlrev_b32 v9, 7, v9
    v_and_b32 v11, 3, v3
    v_lshl_add_u32 v9, v11, 3, v9
    v_add_u32 v9, s63, v9
    v_lshlrev_b32 v11, 4, v2
    v_add_u32 v10, 133120, v11
    v_cmp_eq_u32 vcc, 0, v3
    s_nop 1
    v_cndmask_b32 v13, v12, v11, vcc
    v_lshlrev_b32 v49, 3, v1
    v_add_u32 v49, 133120, v49
    s_barrier
    buffer_load_dwordx4 v[136:139], v5, s[4:7], s96 offen offset:512 nt
    buffer_load_dwordx4 v[140:143], v5, s[4:7], s96 offen offset:640 nt
    s_barrier
    s_add_u32 s96, s48, 32768
    buffer_load_dwordx4 v[144:147], v5, s[4:7], s96 offen offset:0 nt
    buffer_load_dwordx4 v[148:151], v5, s[4:7], s96 offen offset:128 nt
    s_waitcnt vmcnt(11)
    s_cmp_lg_u32 s3, 0
    s_cbranch_scc1 L_ln_skip
    v_dot2_f32_bf16 v16, v32, s57, 0
    v_dot2_f32_bf16 v17, v32, v32, 0
    v_dot2_f32_bf16 v16, v33, s57, v16
    v_dot2_f32_bf16 v17, v33, v33, v17
    v_dot2_f32_bf16 v16, v34, s57, v16
    v_dot2_f32_bf16 v17, v34, v34, v17
    v_dot2_f32_bf16 v16, v35, s57, v16
    v_dot2_f32_bf16 v17, v35, v35, v17
    v_dot2_f32_bf16 v16, v36, s57, v16
    v_dot2_f32_bf16 v17, v36, v36, v17
    v_dot2_f32_bf16 v16, v37, s57, v16
    v_dot2_f32_bf16 v17, v37, v37, v17
    v_dot2_f32_bf16 v16, v38, s57, v16
    v_dot2_f32_bf16 v17, v38, v38, v17
    v_dot2_f32_bf16 v16, v39, s57, v16
    v_dot2_f32_bf16 v17, v39, v39, v17
    v_lshlrev_b32 v20, 16, v40
    v_and_b32 v21, s94, v40
    v_lshlrev_b32 v22, 16, v41
    v_and_b32 v23, s94, v41
    v_add_f32 v16, v16, v16 row_shr:1 row_mask:0xf bank_mask:0xf bound_ctrl:0
    v_add_f32 v17, v17, v17 row_shr:1 row_mask:0xf bank_mask:0xf bound_ctrl:0
    s_nop 0
    v_add_f32 v16, v16, v16 row_shr:2 row_mask:0xf bank_mask:0xf bound_ctrl:0
    v_add_f32 v17, v17, v17 row_shr:2 row_mask:0xf bank_mask:0xf bound_ctrl:0
    s_nop 0
    v_add_f32 v16, v16, v16 row_shr:4 row_mask:0xf bank_mask:0xf bound_ctrl:0
    v_add_f32 v17, v17, v17 row_shr:4 row_mask:0xf bank_mask:0xf bound_ctrl:0
    s_nop 0
    v_add_f32 v16, v16, v16 row_shr:8 row_mask:0xf bank_mask:0xf bound_ctrl:0
    v_add_f32 v17, v17, v17 row_shr:8 row_mask:0xf bank_mask:0xf bound_ctrl:0
    s_nop 0
    v_add_f32 v16, v16, v16 row_bcast:15 row_mask:0xa bank_mask:0xf
    v_add_f32 v17, v17, v17 row_bcast:15 row_mask:0xa bank_mask:0xf
    s_nop 0
    v_add_f32 v16, v16, v16 row_bcast:31 row_mask:0xc bank_mask:0xf
    v_add_f32 v17, v17, v17 row_bcast:31 row_mask:0xc bank_mask:0xf
    v_mov_b32 v19, 0x3a800000
    v_readlane_b32 s90, v16, 63
    v_readlane_b32 s91, v17, 63
    s_nop 0
    v_mul_f32 v18, s90, v19
    v_mul_f32 v19, s91, v19
    v_fma_f32 v19, -v18, v18, v19
    v_max_f32 v19, 0, v19
    v_cvt_pk_bf16_f32 v19, v18, v19
    v_lshlrev_b32 v18, 16, v19
    v_and_b32 v19, s94, v19
    v_add_f32 v19, 0x3727c5ac, v19
    v_cvt_pk_bf16_f32 v19, v19, v19
    v_and_b32 v19, s94, v19
    v_sqrt_f32 v19, v19
    v_sub_f32 v20, v20, v18
    v_sub_f32 v21, v21, v18
    v_sub_f32 v22, v22, v18
    v_sub_f32 v23, v23, v18
    v_cvt_pk_bf16_f32 v19, v19, v19
    v_and_b32 v19, s94, v19
    v_rcp_f32 v19, v19
    v_cvt_pk_bf16_f32 v16, v20, v21
    v_cvt_pk_bf16_f32 v17, v22, v23
    v_lshlrev_b32 v20, 16, v16
    v_and_b32 v21, s94, v16
    v_lshlrev_b32 v22, 16, v17
    v_and_b32 v23, s94, v17
    v_mul_f32 v20, v20, v19
    v_mul_f32 v21, v21, v19
    v_mul_f32 v22, v22, v19
    v_mul_f32 v23, v23, v19
    v_cvt_pk_bf16_f32 v16, v20, v21
    v_cvt_pk_bf16_f32 v17, v22, v23
    ds_write_b64 v49, v[16:17]
L_ln_skip:
    s_barrier
    buffer_load_dwordx4 v[152:155], v5, s[4:7], s96 offen offset:512 nt
    buffer_load_dwordx4 v[156:159], v5, s[4:7], s96 offen offset:640 nt
    s_waitcnt vmcnt(9)
    s_waitcnt lgkmcnt(0)
    s_barrier
    ds_read_b64_tr_b16 v[64:65], v9 offset:0
    ds_read_b64_tr_b16 v[66:67], v9 offset:512
    ds_read_b128 v[96:99], v10 offset:0
    ds_read_b64_tr_b16 v[68:69], v9 offset:4096
    ds_read_b64_tr_b16 v[70:71], v9 offset:4608
    ds_read_b128 v[100:103], v10 offset:64
    ds_read_b64_tr_b16 v[72:73], v9 offset:8192
    ds_read_b64_tr_b16 v[74:75], v9 offset:8704
    ds_read_b128 v[104:107], v10 offset:128
    ds_read_b64_tr_b16 v[76:77], v9 offset:12288
    ds_read_b64_tr_b16 v[78:79], v9 offset:12800
    ds_read_b128 v[108:111], v10 offset:192
    ds_read_b64_tr_b16 v[80:81], v9 offset:16384
    ds_read_b64_tr_b16 v[82:83], v9 offset:16896
    ds_read_b128 v[112:115], v10 offset:256
    ds_read_b64_tr_b16 v[84:85], v9 offset:20480
    ds_read_b64_tr_b16 v[86:87], v9 offset:20992
    ds_read_b128 v[116:119], v10 offset:320
    ds_read_b64_tr_b16 v[88:89], v9 offset:24576
    ds_read_b64_tr_b16 v[90:91], v9 offset:25088
    ds_read_b128 v[120:123], v10 offset:384
    ds_read_b64_tr_b16 v[92:93], v9 offset:28672
    ds_read_b64_tr_b16 v[94:95], v9 offset:29184
    ds_read_b128 v[124:127], v10 offset:448
    s_lshl_b32 s49, s60, 15
    s_lshl_b32 s63, s84, 9
    s_add_u32 s49, s49, s63
    s_lshl_b32 s63, s3, 7
    s_add_u32 s49, s49, s63
    s_add_u32 s49, s49, 0
    s_cmp_ge_u32 s3, 4
    s_cselect_b32 s49, 2097152, s49
    v_lshlrev_b32 v11, 5, v2
    v_lshl_add_u32 v11, v3, 4, v11
    v_cmp_gt_u32 vcc, 2, v3
    s_nop 1
    v_cndmask_b32 v11, v12, v11, vcc
    s_barrier
    s_add_u32 s96, s48, 65536
    buffer_load_dwordx4 v[160:163], v5, s[4:7], s96 offen offset:0 nt
    buffer_load_dwordx4 v[164:167], v5, s[4:7], s96 offen offset:128 nt
    s_waitcnt lgkmcnt(0)
    s_mul_i32 s86, s87, 0x9e3779b1
    s_add_u32 s86, s86, 0x7f4a7c15
    v_mfma_f32_16x16x32_bf16 v[16:19], v[64:67], v[96:99], 0
    v_mfma_f32_16x16x32_bf16 v[16:19], v[68:71], v[100:103], v[16:19]
    v_mfma_f32_16x16x32_bf16 v[16:19], v[72:75], v[104:107], v[16:19]
    v_mfma_f32_16x16x32_bf16 v[16:19], v[76:79], v[108:111], v[16:19]
    v_mfma_f32_16x16x32_bf16 v[16:19], v[80:83], v[112:115], v[16:19]
    v_mfma_f32_16x16x32_bf16 v[16:19], v[84:87], v[116:119], v[16:19]
    v_mfma_f32_16x16x32_bf16 v[16:19], v[88:91], v[120:123], v[16:19]
    v_mfma_f32_16x16x32_bf16 v[16:19], v[92:95], v[124:127], v[16:19]
    v_cmp_eq_u32 vcc, 0, v3
    v_mov_b32 v21, s86
    v_mov_b32 v23, s86
    s_nop 4
    v_cndmask_b32 v20, v18, v16, vcc
    v_cndmask_b32 v22, v19, v17, vcc
    buffer_store_dwordx4 v[20:23], v11, s[36:39], s49 offen sc1
    buffer_store_dwordx4 v[44:47], v48, s[36:39], s101 offen sc1
    s_lshl_b32 s63, s58, 6
    v_mov_b32 v10, s63
    v_cmp_eq_u32 vcc, 0, v0
    s_nop 1
    v_cndmask_b32 v9, v12, v10, vcc
    v_mov_b32 v10, 1
    s_barrier
    s_waitcnt vmcnt(7)
    buffer_load_dwordx4 v[168:171], v5, s[4:7], s96 offen offset:512 nt
    s_waitcnt vmcnt(7)
    buffer_load_dwordx4 v[172:175], v5, s[4:7], s96 offen offset:640 nt
    s_barrier
    s_waitcnt vmcnt(7)
    s_add_u32 s96, s48, 98304
    buffer_load_dwordx4 v[176:179], v5, s[4:7], s96 offen offset:0 nt
    s_waitcnt vmcnt(7)
    buffer_load_dwordx4 v[180:183], v5, s[4:7], s96 offen offset:128 nt
    s_waitcnt vmcnt(4)
    s_barrier
    buffer_atomic_add v10, v9, s[44:47], 0 offen sc1
    s_barrier
    buffer_load_dwordx4 v[184:187], v5, s[4:7], s96 offen offset:512 nt
    buffer_load_dwordx4 v[188:191], v5, s[4:7], s96 offen offset:640 nt
    v_lshrrev_b32 v9, 3, v1
    v_lshlrev_b32 v9, 15, v9
    v_and_b32 v10, 7, v1
    v_lshl_add_u32 v9, v10, 4, v9
    v_cmp_gt_u32 s[88:89], 32, v0
    s_nop 1
    v_cndmask_b32 v9, v12, v9, s[88:89]
    s_lshl_b32 s90, s2, 7
    s_add_u32 s91, s90, 131072
    s_add_u32 s90, s90, 0
    buffer_load_dwordx4 v[32:35], v9, s[36:39], s90 offen sc1
    s_barrier
    s_waitcnt vmcnt(7)
    s_add_u32 s96, s48, 131072
    buffer_load_dwordx4 v[192:195], v5, s[4:7], s96 offen offset:0 nt
    s_waitcnt vmcnt(7)
    buffer_load_dwordx4 v[196:199], v5, s[4:7], s96 offen offset:128 nt
    s_barrier
    s_waitcnt vmcnt(7)
    buffer_load_dwordx4 v[200:203], v5, s[4:7], s96 offen offset:512 nt
    s_waitcnt vmcnt(7)
    buffer_load_dwordx4 v[204:207], v5, s[4:7], s96 offen offset:640 nt
    s_barrier
    s_add_u32 s96, s48, 163840
    buffer_load_dwordx4 v[208:211], v5, s[4:7], s96 offen offset:0 nt
    buffer_load_dwordx4 v[212:215], v5, s[4:7], s96 offen offset:128 nt
    s_waitcnt vmcnt(6)
    v_xor_b32 v16, s86, v33
    v_xor_b32 v17, s86, v35
    v_or_b32 v16, v16, v17
    v_cmp_ne_u32 vcc, 0, v16
    s_nop 0
    s_and_b64 vcc, vcc, s[88:89]
    s_cbranch_vccz L_q2_ok
    s_mov_b32 s62, 0x40000
L_q2_spin:
    buffer_load_dwordx4 v[32:35], v9, s[36:39], s90 offen sc1
    s_waitcnt vmcnt(0)
    s_sub_u32 s62, s62, 1
    s_cbranch_scc1 L_q2_ok
    v_xor_b32 v16, s86, v33
    v_xor_b32 v17, s86, v35
    v_or_b32 v16, v16, v17
    v_cmp_ne_u32 vcc, 0, v16
    s_nop 0
    s_and_b64 vcc, vcc, s[88:89]
    s_cbranch_vccnz L_q2_spin
L_q2_ok:
    v_add_f32 v32, v32, v32 row_ror:8 row_mask:0xf bank_mask:0xf
    v_add_f32 v34, v34, v34 row_ror:8 row_mask:0xf bank_mask:0xf
    v_mov_b32 v16, v32
    v_mov_b32 v17, v34
    v_lshlrev_b32 v10, 3, v0
    v_cmp_gt_u32 vcc, 8, v0
    v_permlane16_swap_b32 v32, v16
    v_permlane16_swap_b32 v34, v17
    v_cndmask_b32 v11, v12, v10, vcc
    v_add_f32 v32, v32, v16
    v_add_f32 v34, v34, v17
    v_mov_b32 v17, s86
    v_cvt_pk_bf16_f32 v16, v32, v34
    buffer_store_dwordx2 v[16:17], v11, s[36:39], s91 offen sc1
    s_barrier
    buffer_load_dwordx4 v[216:219], v5, s[4:7], s96 offen offset:512 nt
    s_waitcnt vmcnt(7)
    buffer_load_dwordx4 v[220:223], v5, s[4:7], s96 offen offset:640 nt
    s_barrier
    s_waitcnt vmcnt(7)
    s_add_u32 s96, s48, 196608
    buffer_load_dwordx4 v[224:227], v5, s[4:7], s96 offen offset:0 nt
    s_waitcnt vmcnt(7)
    buffer_load_dwordx4 v[228:231], v5, s[4:7], s96 offen offset:128 nt
    s_barrier
    s_waitcnt vmcnt(7)
    buffer_load_dwordx4 v[232:235], v5, s[4:7], s96 offen offset:512 nt
    s_waitcnt vmcnt(7)
    buffer_load_dwordx4 v[236:239], v5, s[4:7], s96 offen offset:640 nt
    s_barrier
    s_waitcnt vmcnt(7)
    s_add_u32 s96, s48, 229376
    buffer_load_dwordx4 v[240:243], v5, s[4:7], s96 offen offset:0 nt
    buffer_load_dwordx4 v[244:247], v5, s[4:7], s96 offen offset:128 nt
    s_barrier
    buffer_load_dwordx4 v[248:251], v5, s[4:7], s96 offen offset:512 nt
    v_lshrrev_b32 v9, 3, v0
    v_lshlrev_b32 v9, 7, v9
    v_and_b32 v10, 7, v0
    v_lshl_add_u32 v9, v10, 3, v9
    s_lshl_b32 s90, s58, 13
    s_add_u32 s90, s90, 131072
    buffer_load_dwordx2 v[32:33], v9, s[36:39], s90 offen sc1
    v_and_b32 v15, 3, v1
    v_lshlrev_b32 v15, 6, v15
    s_cmp_eq_u32 s3, 0
    s_cselect_b32 s91, 0, 0x1000
    buffer_load_dword v14, v15, s[44:47], s91 offen sc1
    buffer_load_dwordx4 v[252:255], v5, s[4:7], s96 offen offset:640 nt
    s_barrier
    s_add_u32 s97, s48, 0
    buffer_load_dwordx4 v[64:67], v6, s[8:11], s97 offen offset:0 nt
    buffer_load_dwordx4 v[68:71], v6, s[8:11], s97 offen offset:1024 nt
    s_barrier
    s_waitcnt vmcnt(7)
    buffer_load_dwordx4 v[72:75], v6, s[8:11], s97 offen offset:2048 nt
    s_waitcnt vmcnt(7)
    buffer_load_dwordx4 v[76:79], v6, s[8:11], s97 offen offset:3072 nt
    s_barrier
    s_waitcnt vmcnt(7)
    s_add_u32 s97, s48, 32768
    buffer_load_dwordx4 v[80:83], v6, s[8:11], s97 offen offset:0 nt
    s_waitcnt vmcnt(7)
    v_cmp_ne_u32 vcc, s86, v33
    s_cbranch_vccz L_q_ok
    s_mov_b32 s62, 0x40000
L_q_spin:
    buffer_load_dwordx2 v[32:33], v9, s[36:39], s90 offen sc1
    s_waitcnt vmcnt(0)
    s_sub_u32 s62, s62, 1
    s_cbranch_scc1 L_q_ok
    v_cmp_ne_u32 vcc, s86, v33
    s_cbranch_vccnz L_q_spin
L_q_ok:
    v_lshlrev_b32 v9, 2, v0
    v_add_u32 v9, 133632, v9
    ds_write_b32 v9, v32
    v_and_b32 v10, 7, v3
    v_lshlrev_b32 v9, 8, v10
    v_lshrrev_b32 v10, 3, v3
    v_lshl_add_u32 v9, v10, 6, v9
    v_lshl_add_u32 v9, v2, 4, v9
    v_add_u32 v9, 133632, v9
    s_waitcnt lgkmcnt(0)
    s_barrier
    ds_read_b128 v[24:27], v9
    ds_read_b128 v[28:31], v9 offset:128
    s_mov_b32 s62, 1035273459
    s_waitcnt lgkmcnt(0)
    v_mfma_f32_16x16x32_bf16 v[32:35], v[128:131], v[24:27], 0
    v_mfma_f32_16x16x32_bf16 v[16:19], v[136:139], v[24:27], 0
    v_mfma_f32_16x16x32_bf16 v[32:35], v[132:135], v[28:31], v[32:35]
    v_mfma_f32_16x16x32_bf16 v[16:19], v[140:143], v[28:31], v[16:19]
    v_mfma_f32_16x16x32_bf16 v[20:23], v[144:147], v[24:27], 0
    v_mfma_f32_16x16x32_bf16 v[36:39], v[152:155], v[24:27], 0
    v_mfma_f32_16x16x32_bf16 v[20:23], v[148:151], v[28:31], v[20:23]
    v_mfma_f32_16x16x32_bf16 v[36:39], v[156:159], v[28:31], v[36:39]
    s_nop 3
    v_permlane32_swap_b32 v32, v16
    v_permlane32_swap_b32 v33, v17
    v_permlane32_swap_b32 v34, v18
    v_permlane32_swap_b32 v35, v19
    v_permlane32_swap_b32 v20, v36
    v_permlane32_swap_b32 v21, v37
    v_permlane32_swap_b32 v22, v38
    v_permlane32_swap_b32 v23, v39
    v_add_f32 v36, v20, v36 row_ror:8 row_mask:0xf bank_mask:0xc
    v_add_f32 v37, v21, v37 row_ror:8 row_mask:0xf bank_mask:0xc
    v_add_f32 v38, v22, v38 row_ror:8 row_mask:0xf bank_mask:0xc
    v_add_f32 v39, v23, v39 row_ror:8 row_mask:0xf bank_mask:0xc
    v_add_f32 v36, v16, v32 row_ror:8 row_mask:0xf bank_mask:0x3
    v_add_f32 v37, v17, v33 row_ror:8 row_mask:0xf bank_mask:0x3
    v_add_f32 v38, v18, v34 row_ror:8 row_mask:0xf bank_mask:0x3
    v_add_f32 v39, v19, v35 row_ror:8 row_mask:0xf bank_mask:0x3
    v_mfma_f32_16x16x32_bf16 v[40:43], v[160:163], v[24:27], 0
    v_mfma_f32_16x16x32_bf16 v[16:19], v[168:171], v[24:27], 0
    v_mfma_f32_16x16x32_bf16 v[40:43], v[164:167], v[28:31], v[40:43]
    v_mfma_f32_16x16x32_bf16 v[16:19], v[172:175], v[28:31], v[16:19]
    v_mfma_f32_16x16x32_bf16 v[20:23], v[176:179], v[24:27], 0
    v_mfma_f32_16x16x32_bf16 v[44:47], v[184:187], v[24:27], 0
    v_mfma_f32_16x16x32_bf16 v[20:23], v[180:183], v[28:31], v[20:23]
    v_mfma_f32_16x16x32_bf16 v[44:47], v[188:191], v[28:31], v[44:47]
    v_cvt_pk_bf16_f32 v9, v36, v37
    v_cvt_pk_bf16_f32 v10, v38, v39
    v_lshlrev_b32 v36, 16, v9
    v_and_b32 v37, s94, v9
    v_lshlrev_b32 v38, 16, v10
    v_and_b32 v39, s94, v10
    v_mul_f32 v36, s62, v36
    v_mul_f32 v37, s62, v37
    v_mul_f32 v38, s62, v38
    v_mul_f32 v39, s62, v39
    v_cvt_pk_bf16_f32 v9, v36, v37
    v_cvt_pk_bf16_f32 v10, v38, v39
    v_lshlrev_b32 v36, 16, v9
    v_and_b32 v37, s94, v9
    v_lshlrev_b32 v38, 16, v10
    v_and_b32 v39, s94, v10
    v_max3_f32 v12, v36, v37, v38
    v_max_f32 v12, v12, v39
    buffer_load_dwordx4 v[84:87], v6, s[8:11], s97 offen offset:1024 nt
    v_permlane32_swap_b32 v40, v16
    v_permlane32_swap_b32 v41, v17
    v_permlane32_swap_b32 v42, v18
    v_permlane32_swap_b32 v43, v19
    v_permlane32_swap_b32 v20, v44
    v_permlane32_swap_b32 v21, v45
    v_permlane32_swap_b32 v22, v46
    v_permlane32_swap_b32 v23, v47
    v_add_f32 v44, v20, v44 row_ror:8 row_mask:0xf bank_mask:0xc
    v_add_f32 v45, v21, v45 row_ror:8 row_mask:0xf bank_mask:0xc
    v_add_f32 v46, v22, v46 row_ror:8 row_mask:0xf bank_mask:0xc
    v_add_f32 v47, v23, v47 row_ror:8 row_mask:0xf bank_mask:0xc
    v_add_f32 v44, v16, v40 row_ror:8 row_mask:0xf bank_mask:0x3
    v_add_f32 v45, v17, v41 row_ror:8 row_mask:0xf bank_mask:0x3
    v_add_f32 v46, v18, v42 row_ror:8 row_mask:0xf bank_mask:0x3
    v_add_f32 v47, v19, v43 row_ror:8 row_mask:0xf bank_mask:0x3
    v_mfma_f32_16x16x32_bf16 v[48:51], v[192:195], v[24:27], 0
    v_mfma_f32_16x16x32_bf16 v[16:19], v[200:203], v[24:27], 0
    v_mfma_f32_16x16x32_bf16 v[48:51], v[196:199], v[28:31], v[48:51]
    v_mfma_f32_16x16x32_bf16 v[16:19], v[204:207], v[28:31], v[16:19]
    v_mfma_f32_16x16x32_bf16 v[20:23], v[208:211], v[24:27], 0
    v_mfma_f32_16x16x32_bf16 v[52:55], v[216:219], v[24:27], 0
    v_mfma_f32_16x16x32_bf16 v[20:23], v[212:215], v[28:31], v[20:23]
    v_mfma_f32_16x16x32_bf16 v[52:55], v[220:223], v[28:31], v[52:55]
    v_cvt_pk_bf16_f32 v9, v44, v45
    v_cvt_pk_bf16_f32 v10, v46, v47
    v_lshlrev_b32 v44, 16, v9
    v_and_b32 v45, s94, v9
    v_lshlrev_b32 v46, 16, v10
    v_and_b32 v47, s94, v10
    v_mul_f32 v44, s62, v44
    v_mul_f32 v45, s62, v45
    v_mul_f32 v46, s62, v46
    v_mul_f32 v47, s62, v47
    v_cvt_pk_bf16_f32 v9, v44, v45
    v_cvt_pk_bf16_f32 v10, v46, v47
    v_lshlrev_b32 v44, 16, v9
    v_and_b32 v45, s94, v9
    v_lshlrev_b32 v46, 16, v10
    v_and_b32 v47, s94, v10
    v_max3_f32 v12, v12, v44, v45
    v_max3_f32 v12, v12, v46, v47
    s_barrier
    s_waitcnt vmcnt(7)
    buffer_load_dwordx4 v[88:91], v6, s[8:11], s97 offen offset:2048 nt
    v_permlane32_swap_b32 v48, v16
    v_permlane32_swap_b32 v49, v17
    v_permlane32_swap_b32 v50, v18
    v_permlane32_swap_b32 v51, v19
    v_permlane32_swap_b32 v20, v52
    v_permlane32_swap_b32 v21, v53
    v_permlane32_swap_b32 v22, v54
    v_permlane32_swap_b32 v23, v55
    v_add_f32 v52, v20, v52 row_ror:8 row_mask:0xf bank_mask:0xc
    v_add_f32 v53, v21, v53 row_ror:8 row_mask:0xf bank_mask:0xc
    v_add_f32 v54, v22, v54 row_ror:8 row_mask:0xf bank_mask:0xc
    v_add_f32 v55, v23, v55 row_ror:8 row_mask:0xf bank_mask:0xc
    v_add_f32 v52, v16, v48 row_ror:8 row_mask:0xf bank_mask:0x3
    v_add_f32 v53, v17, v49 row_ror:8 row_mask:0xf bank_mask:0x3
    v_add_f32 v54, v18, v50 row_ror:8 row_mask:0xf bank_mask:0x3
    v_add_f32 v55, v19, v51 row_ror:8 row_mask:0xf bank_mask:0x3
    v_mfma_f32_16x16x32_bf16 v[56:59], v[224:227], v[24:27], 0
    v_mfma_f32_16x16x32_bf16 v[16:19], v[232:235], v[24:27], 0
    v_mfma_f32_16x16x32_bf16 v[56:59], v[228:231], v[28:31], v[56:59]
    v_mfma_f32_16x16x32_bf16 v[16:19], v[236:239], v[28:31], v[16:19]
    s_waitcnt vmcnt(7)
    v_mfma_f32_16x16x32_bf16 v[20:23], v[240:243], v[24:27], 0
    v_mfma_f32_16x16x32_bf16 v[60:63], v[248:251], v[24:27], 0
    v_mfma_f32_16x16x32_bf16 v[20:23], v[244:247], v[28:31], v[20:23]
    v_mfma_f32_16x16x32_bf16 v[60:63], v[252:255], v[28:31], v[60:63]
    v_cvt_pk_bf16_f32 v9, v52, v53
    v_cvt_pk_bf16_f32 v10, v54, v55
    v_lshlrev_b32 v52, 16, v9
    v_and_b32 v53, s94, v9
    v_lshlrev_b32 v54, 16, v10
    v_and_b32 v55, s94, v10
    v_mul_f32 v52, s62, v52
    v_mul_f32 v53, s62, v53
    v_mul_f32 v54, s62, v54
    v_mul_f32 v55, s62, v55
    v_cvt_pk_bf16_f32 v9, v52, v53
    v_cvt_pk_bf16_f32 v10, v54, v55
    v_lshlrev_b32 v52, 16, v9
    v_and_b32 v53, s94, v9
    v_lshlrev_b32 v54, 16, v10
    v_and_b32 v55, s94, v10
    v_max3_f32 v12, v12, v52, v53
    v_max3_f32 v12, v12, v54, v55
    buffer_load_dwordx4 v[92:95], v6, s[8:11], s97 offen offset:3072 nt
    v_permlane32_swap_b32 v56, v16
    v_permlane32_swap_b32 v57, v17
    v_permlane32_swap_b32 v58, v18
    v_permlane32_swap_b32 v59, v19
    v_permlane32_swap_b32 v20, v60
    v_permlane32_swap_b32 v21, v61
    v_permlane32_swap_b32 v22, v62
    v_permlane32_swap_b32 v23, v63
    v_add_f32 v60, v20, v60 row_ror:8 row_mask:0xf bank_mask:0xc
    v_add_f32 v61, v21, v61 row_ror:8 row_mask:0xf bank_mask:0xc
    v_add_f32 v62, v22, v62 row_ror:8 row_mask:0xf bank_mask:0xc
    v_add_f32 v63, v23, v63 row_ror:8 row_mask:0xf bank_mask:0xc
    v_add_f32 v60, v16, v56 row_ror:8 row_mask:0xf bank_mask:0x3
    v_add_f32 v61, v17, v57 row_ror:8 row_mask:0xf bank_mask:0x3
    v_add_f32 v62, v18, v58 row_ror:8 row_mask:0xf bank_mask:0x3
    v_add_f32 v63, v19, v59 row_ror:8 row_mask:0xf bank_mask:0x3
    v_cvt_pk_bf16_f32 v9, v60, v61
    v_cvt_pk_bf16_f32 v10, v62, v63
    v_lshlrev_b32 v60, 16, v9
    v_and_b32 v61, s94, v9
    v_lshlrev_b32 v62, 16, v10
    v_and_b32 v63, s94, v10
    v_mul_f32 v60, s62, v60
    v_mul_f32 v61, s62, v61
    v_mul_f32 v62, s62, v62
    v_mul_f32 v63, s62, v63
    v_cvt_pk_bf16_f32 v9, v60, v61
    v_cvt_pk_bf16_f32 v10, v62, v63
    v_lshlrev_b32 v60, 16, v9
    v_and_b32 v61, s94, v9
    v_lshlrev_b32 v62, 16, v10
    v_and_b32 v63, s94, v10
    v_max3_f32 v12, v12, v60, v61
    v_max3_f32 v12, v12, v62, v63
    s_barrier
    s_waitcnt vmcnt(7)
    s_add_u32 s97, s48, 65536
    buffer_load_dwordx4 v[96:99], v6, s[8:11], s97 offen offset:0 nt
    v_max_f32 v12, v12, v12 row_ror:8 row_mask:0xf bank_mask:0xf
    v_mov_b32 v9, v12
    s_nop 1
    v_permlane16_swap_b32 v12, v9
    v_max_f32 v12, v12, v9
    v_mov_b32 v9, v12
    s_nop 1
    v_permlane32_swap_b32 v12, v9
    v_max_f32 v12, v12, v9
    v_sub_f32 v36, v36, v12
    v_sub_f32 v37, v37, v12
    v_sub_f32 v38, v38, v12
    v_sub_f32 v39, v39, v12
    v_sub_f32 v44, v44, v12
    v_sub_f32 v45, v45, v12
    v_sub_f32 v46, v46, v12
    v_sub_f32 v47, v47, v12
    v_mul_f32 v36, s98, v36
    v_mul_f32 v37, s98, v37
    v_mul_f32 v38, s98, v38
    v_mul_f32 v39, s98, v39
    v_mul_f32 v44, s98, v44
    v_mul_f32 v45, s98, v45
    v_mul_f32 v46, s98, v46
    v_mul_f32 v47, s98, v47
    v_exp_f32 v36, v36
    v_exp_f32 v37, v37
    v_exp_f32 v38, v38
    v_exp_f32 v39, v39
    v_exp_f32 v44, v44
    v_exp_f32 v45, v45
    v_exp_f32 v46, v46
    v_exp_f32 v47, v47
    s_waitcnt vmcnt(7)
    buffer_load_dwordx4 v[100:103], v6, s[8:11], s97 offen offset:1024 nt
    v_sub_f32 v52, v52, v12
    v_sub_f32 v53, v53, v12
    v_sub_f32 v54, v54, v12
    v_sub_f32 v55, v55, v12
    v_sub_f32 v60, v60, v12
    v_sub_f32 v61, v61, v12
    v_sub_f32 v62, v62, v12
    v_sub_f32 v63, v63, v12
    v_mul_f32 v52, s98, v52
    v_mul_f32 v53, s98, v53
    v_mul_f32 v54, s98, v54
    v_mul_f32 v55, s98, v55
    v_mul_f32 v60, s98, v60
    v_mul_f32 v61, s98, v61
    v_mul_f32 v62, s98, v62
    v_mul_f32 v63, s98, v63
    v_exp_f32 v52, v52
    v_exp_f32 v53, v53
    v_exp_f32 v54, v54
    v_exp_f32 v55, v55
    v_exp_f32 v60, v60
    v_exp_f32 v61, v61
    v_exp_f32 v62, v62
    v_exp_f32 v63, v63
    s_barrier
    s_waitcnt vmcnt(7)
    buffer_load_dwordx4 v[104:107], v6, s[8:11], s97 offen offset:2048 nt
    v_pk_add_f32 v[16:17], v[36:37], v[44:45]
    v_pk_add_f32 v[18:19], v[38:39], v[46:47]
    v_pk_add_f32 v[20:21], v[52:53], v[60:61]
    v_pk_add_f32 v[22:23], v[54:55], v[62:63]
    v_pk_add_f32 v[16:17], v[16:17], v[18:19]
    v_pk_add_f32 v[20:21], v[20:21], v[22:23]
    v_pk_add_f32 v[16:17], v[16:17], v[20:21]
    v_add_f32 v19, v16, v17
    s_nop 1
    v_add_f32 v19, v19, v19 row_ror:8 row_mask:0xf bank_mask:0xf
    v_mov_b32 v9, v19
    s_nop 1
    v_permlane16_swap_b32 v19, v9
    v_add_f32 v19, v19, v9
    v_mov_b32 v9, v19
    s_nop 1
    v_permlane32_swap_b32 v19, v9
    v_add_f32 v19, v19, v9
    v_mov_b32 v18, v12
    s_lshl_b32 s63, s3, 6
    s_add_u32 s63, s63, 135680
    v_lshlrev_b32 v9, 3, v1
    v_add_u32 v16, s63, v9
    s_mov_b64 exec, 0xff
    ds_write_b64 v16, v[18:19]
    s_mov_b64 exec, -1
    v_add_u32 v9, 135680, v9
    s_cmp_lg_u32 s3, 0
    s_cbranch_scc1 L_cnt_ok
    v_cmp_gt_u32 vcc, 64, v14
    s_cbranch_vccz L_cnt_ok
    s_mov_b32 s62, 0x10000
L_cnt_spin:
    s_sleep 32
    buffer_load_dword v14, v15, s[44:47], 0 offen sc1
    s_waitcnt vmcnt(0)
    s_sub_u32 s62, s62, 1
    s_cbranch_scc1 L_cnt_ok
    v_cmp_gt_u32 vcc, 64, v14
    s_cbranch_vccnz L_cnt_spin
L_cnt_ok:
    s_waitcnt lgkmcnt(0)
    s_barrier
    ds_read_b64 v[16:17], v9
    s_lshl_b32 s49, s2, 7
    s_add_u32 s49, s49, 1507328
    s_waitcnt lgkmcnt(0)
    v_max_f32 v18, v16, v16 row_ror:8 row_mask:0xf bank_mask:0xf
    v_max_f32 v18, v18, v16
    v_mov_b32 v10, v18
    s_nop 1
    v_permlane16_swap_b32 v18, v10
    v_max_f32 v18, v18, v10
    v_mov_b32 v10, v18
    s_nop 1
    v_permlane32_swap_b32 v18, v10
    v_max_f32 v18, v18, v10
    v_sub_f32 v16, v16, v18
    v_mul_f32 v16, s98, v16
    v_exp_f32 v16, v16
    s_nop 0
    v_mul_f32 v19, v16, v17
    s_nop 1
    v_add_f32 v19, v19, v19 row_ror:8 row_mask:0xf bank_mask:0xf
    v_mov_b32 v10, v19
    s_nop 1
    v_permlane16_swap_b32 v19, v10
    v_add_f32 v19, v19, v10
    v_mov_b32 v10, v19
    s_nop 1
    v_permlane32_swap_b32 v19, v10
    v_add_f32 v19, v19, v10
    v_min_u32 v18, -2, v18
    v_min_u32 v19, -2, v19
    buffer_store_dwordx2 v[18:19], v11, s[36:39], s49 offen sc1
    s_waitcnt vmcnt(7)
    buffer_load_dwordx4 v[108:111], v6, s[8:11], s97 offen offset:3072 nt
    s_barrier
    s_waitcnt vmcnt(7)
    s_add_u32 s97, s48, 98304
    buffer_load_dwordx4 v[112:115], v6, s[8:11], s97 offen offset:0 nt
    s_waitcnt vmcnt(7)
    buffer_load_dwordx4 v[116:119], v6, s[8:11], s97 offen offset:1024 nt
    s_barrier
    s_waitcnt vmcnt(7)
    buffer_load_dwordx4 v[120:123], v6, s[8:11], s97 offen offset:2048 nt
    s_waitcnt vmcnt(7)
    buffer_load_dwordx4 v[124:127], v6, s[8:11], s97 offen offset:3072 nt
    s_barrier
    s_waitcnt vmcnt(7)
    s_add_u32 s97, s48, 131072
    buffer_load_dwordx4 v[128:131], v6, s[8:11], s97 offen offset:0 nt
    s_waitcnt vmcnt(7)
    buffer_load_dwordx4 v[132:135], v6, s[8:11], s97 offen offset:1024 nt
    v_lshrrev_b32 v9, 3, v0
    v_lshlrev_b32 v9, 7, v9
    v_and_b32 v10, 7, v0
    v_lshl_add_u32 v9, v10, 3, v9
    s_lshl_b32 s90, s58, 13
    s_add_u32 s90, s90, 1507328
    buffer_load_dwordx2 v[16:17], v9, s[36:39], s90 offen sc1
    s_barrier
    buffer_load_dwordx4 v[136:139], v6, s[8:11], s97 offen offset:2048 nt
    buffer_load_dwordx4 v[140:143], v6, s[8:11], s97 offen offset:3072 nt
    s_barrier
    s_add_u32 s97, s48, 163840
    buffer_load_dwordx4 v[144:147], v6, s[8:11], s97 offen offset:0 nt
    buffer_load_dwordx4 v[148:151], v6, s[8:11], s97 offen offset:1024 nt
    s_barrier
    buffer_load_dwordx4 v[152:155], v6, s[8:11], s97 offen offset:2048 nt
    buffer_load_dwordx4 v[156:159], v6, s[8:11], s97 offen offset:3072 nt
    s_waitcnt vmcnt(6)
    v_max_u32 v18, v16, v17
    v_cmp_eq_u32 vcc, -1, v18
    s_cbranch_vccz L_ml_ok
    s_mov_b32 s62, 0x40000
L_ml_spin:
    buffer_load_dwordx2 v[16:17], v9, s[36:39], s90 offen sc1
    s_waitcnt vmcnt(0)
    s_sub_u32 s62, s62, 1
    s_cbranch_scc1 L_ml_ok
    v_max_u32 v18, v16, v17
    v_cmp_eq_u32 vcc, -1, v18
    s_cbranch_vccnz L_ml_spin
L_ml_ok:
    s_barrier
    s_add_u32 s97, s48, 196608
    buffer_load_dwordx4 v[160:163], v6, s[8:11], s97 offen offset:0 nt
    v_max_f32 v18, v16, v16 row_ror:8 row_mask:0xf bank_mask:0xf
    v_max_f32 v18, v18, v16
    v_mov_b32 v10, v18
    s_nop 1
    v_permlane16_swap_b32 v18, v10
    v_max_f32 v18, v18, v10
    v_mov_b32 v10, v18
    s_nop 1
    v_permlane32_swap_b32 v18, v10
    v_max_f32 v18, v18, v10
    v_sub_f32 v16, v16, v18
    v_mul_f32 v16, s98, v16
    v_exp_f32 v16, v16
    s_nop 0
    v_mul_f32 v19, v16, v17
    s_nop 1
    v_add_f32 v19, v19, v19 row_ror:8 row_mask:0xf bank_mask:0xf
    v_mov_b32 v10, v19
    s_nop 1
    v_permlane16_swap_b32 v19, v10
    v_add_f32 v19, v19, v10
    v_mov_b32 v10, v19
    s_nop 1
    v_permlane32_swap_b32 v19, v10
    v_add_f32 v19, v19, v10
    s_lshl_b32 s63, s3, 6
    s_add_u32 s63, s63, 136192
    v_lshlrev_b32 v9, 3, v1
    v_add_u32 v16, s63, v9
    s_mov_b64 exec, 0xff
    ds_write_b64 v16, v[18:19]
    s_mov_b64 exec, -1
    v_add_u32 v9, 136192, v9
    s_waitcnt lgkmcnt(0)
    s_barrier
    ds_read_b64 v[16:17], v9
    buffer_load_dwordx4 v[164:167], v6, s[8:11], s97 offen offset:1024 nt
    s_waitcnt lgkmcnt(0)
    v_max_f32 v18, v16, v16 row_ror:8 row_mask:0xf bank_mask:0xf
    v_max_f32 v18, v18, v16
    v_mov_b32 v10, v18
    s_nop 1
    v_permlane16_swap_b32 v18, v10
    v_max_f32 v18, v18, v10
    v_mov_b32 v10, v18
    s_nop 1
    v_permlane32_swap_b32 v18, v10
    v_max_f32 v18, v18, v10
    v_sub_f32 v16, v16, v18
    v_mul_f32 v16, s98, v16
    v_exp_f32 v16, v16
    s_nop 0
    v_mul_f32 v19, v16, v17
    s_nop 1
    v_add_f32 v19, v19, v19 row_ror:8 row_mask:0xf bank_mask:0xf
    v_mov_b32 v10, v19
    s_nop 1
    v_permlane16_swap_b32 v19, v10
    v_add_f32 v19, v19, v10
    v_mov_b32 v10, v19
    s_nop 1
    v_permlane32_swap_b32 v19, v10
    v_add_f32 v19, v19, v10
    v_rcp_f32 v19, v19
    v_sub_f32 v16, v12, v18
    v_mul_f32 v16, s98, v16
    v_exp_f32 v16, v16
    v_lshrrev_b32 v15, 3, v3
    v_lshl_add_u32 v15, v2, 2, v15
    v_mul_u32_u24 v15, 1056, v15
    v_bfe_u32 v10, v3, 2, 1
    v_lshl_add_u32 v15, v10, 9, v15
    v_and_b32 v10, 3, v3
    v_lshl_add_u32 v15, v10, 3, v15
    s_lshl_b32 s63, s3, 6
    v_add_u32 v15, s63, v15
    v_mul_f32 v16, v16, v19
    s_barrier
    s_waitcnt vmcnt(7)
    buffer_load_dwordx4 v[168:171], v6, s[8:11], s97 offen offset:2048 nt
    v_mul_f32 v36, v36, v16
    v_mul_f32 v37, v37, v16
    v_mul_f32 v38, v38, v16
    v_mul_f32 v39, v39, v16
    v_mul_f32 v44, v44, v16
    v_mul_f32 v45, v45, v16
    v_mul_f32 v46, v46, v16
    v_mul_f32 v47, v47, v16
    v_mul_f32 v52, v52, v16
    v_mul_f32 v53, v53, v16
    v_mul_f32 v54, v54, v16
    v_mul_f32 v55, v55, v16
    v_mul_f32 v60, v60, v16
    v_mul_f32 v61, v61, v16
    v_mul_f32 v62, v62, v16
    v_mul_f32 v63, v63, v16
    v_cvt_pk_bf16_f32 v32, v36, v37
    v_cvt_pk_bf16_f32 v33, v38, v39
    v_cvt_pk_bf16_f32 v40, v44, v45
    v_cvt_pk_bf16_f32 v41, v46, v47
    v_cvt_pk_bf16_f32 v48, v52, v53
    v_cvt_pk_bf16_f32 v49, v54, v55
    v_cvt_pk_bf16_f32 v56, v60, v61
    v_cvt_pk_bf16_f32 v57, v62, v63
    v_mov_b32 v34, v32 row_ror:8 row_mask:0xf bank_mask:0xf
    v_mov_b32 v35, v33 row_ror:8 row_mask:0xf bank_mask:0xf
    v_mov_b32 v42, v40 row_ror:8 row_mask:0xf bank_mask:0xf
    v_mov_b32 v43, v41 row_ror:8 row_mask:0xf bank_mask:0xf
    v_mov_b32 v50, v48 row_ror:8 row_mask:0xf bank_mask:0xf
    v_mov_b32 v51, v49 row_ror:8 row_mask:0xf bank_mask:0xf
    v_mov_b32 v58, v56 row_ror:8 row_mask:0xf bank_mask:0xf
    v_mov_b32 v59, v57 row_ror:8 row_mask:0xf bank_mask:0xf
    s_waitcnt vmcnt(7)
    buffer_load_dwordx4 v[172:175], v6, s[8:11], s97 offen offset:3072 nt
    v_mov_b32 v12, 2147483632
    v_lshlrev_b32 v9, 6, v3
    v_lshl_add_u32 v9, v2, 4, v9
    v_cmp_gt_u32 vcc, 2, v3
    s_nop 1
    v_cndmask_b32 v14, v12, v9, vcc
    v_add_u32 v11, 99328, v15
    v_perm_b32 v192, v68, v64, s55
    v_perm_b32 v196, v68, v64, s56
    v_perm_b32 v200, v69, v65, s55
    v_perm_b32 v204, v69, v65, s56
    v_perm_b32 v208, v70, v66, s55
    v_perm_b32 v212, v70, v66, s56
    v_perm_b32 v216, v71, v67, s55
    v_perm_b32 v220, v71, v67, s56
    v_perm_b32 v193, v76, v72, s55
    v_perm_b32 v197, v76, v72, s56
    v_perm_b32 v201, v77, v73, s55
    v_perm_b32 v205, v77, v73, s56
    v_perm_b32 v209, v78, v74, s55
    v_perm_b32 v213, v78, v74, s56
    v_perm_b32 v217, v79, v75, s55
    v_perm_b32 v221, v79, v75, s56
    v_perm_b32 v194, v84, v80, s55
    v_perm_b32 v198, v84, v80, s56
    v_perm_b32 v202, v85, v81, s55
    v_perm_b32 v206, v85, v81, s56
    v_perm_b32 v210, v86, v82, s55
    v_perm_b32 v214, v86, v82, s56
    v_perm_b32 v218, v87, v83, s55
    v_perm_b32 v222, v87, v83, s56
    v_perm_b32 v195, v92, v88, s55
    v_perm_b32 v199, v92, v88, s56
    v_perm_b32 v203, v93, v89, s55
    v_perm_b32 v207, v93, v89, s56
    v_perm_b32 v211, v94, v90, s55
    v_perm_b32 v215, v94, v90, s56
    v_perm_b32 v219, v95, v91, s55
    v_perm_b32 v223, v95, v91, s56
    v_mfma_f32_16x16x32_bf16 v[224:227], v[192:195], v[32:35], 0
    v_mfma_f32_16x16x32_bf16 v[240:243], v[208:211], v[32:35], 0
    v_mfma_f32_16x16x32_bf16 v[228:231], v[196:199], v[32:35], 0
    v_mfma_f32_16x16x32_bf16 v[244:247], v[212:215], v[32:35], 0
    v_mfma_f32_16x16x32_bf16 v[232:235], v[200:203], v[32:35], 0
    v_mfma_f32_16x16x32_bf16 v[248:251], v[216:219], v[32:35], 0
    v_mfma_f32_16x16x32_bf16 v[236:239], v[204:207], v[32:35], 0
    v_mfma_f32_16x16x32_bf16 v[252:255], v[220:223], v[32:35], 0
    v_perm_b32 v192, v100, v96, s55
    v_perm_b32 v196, v100, v96, s56
    v_perm_b32 v200, v101, v97, s55
    v_perm_b32 v204, v101, v97, s56
    v_perm_b32 v208, v102, v98, s55
    v_perm_b32 v212, v102, v98, s56
    v_perm_b32 v216, v103, v99, s55
    v_perm_b32 v220, v103, v99, s56
    v_perm_b32 v193, v108, v104, s55
    v_perm_b32 v197, v108, v104, s56
    v_perm_b32 v201, v109, v105, s55
    v_perm_b32 v205, v109, v105, s56
    v_perm_b32 v209, v110, v106, s55
    v_perm_b32 v213, v110, v106, s56
    v_perm_b32 v217, v111, v107, s55
    v_perm_b32 v221, v111, v107, s56
    v_perm_b32 v194, v116, v112, s55
    v_perm_b32 v198, v116, v112, s56
    v_perm_b32 v202, v117, v113, s55
    v_perm_b32 v206, v117, v113, s56
    v_perm_b32 v210, v118, v114, s55
    v_perm_b32 v214, v118, v114, s56
    v_perm_b32 v218, v119, v115, s55
    v_perm_b32 v222, v119, v115, s56
    v_perm_b32 v195, v124, v120, s55
    v_perm_b32 v199, v124, v120, s56
    v_perm_b32 v203, v125, v121, s55
    v_perm_b32 v207, v125, v121, s56
    v_perm_b32 v211, v126, v122, s55
    v_perm_b32 v215, v126, v122, s56
    v_perm_b32 v219, v127, v123, s55
    v_perm_b32 v223, v127, v123, s56
    v_mfma_f32_16x16x32_bf16 v[224:227], v[192:195], v[40:43], v[224:227]
    v_mfma_f32_16x16x32_bf16 v[240:243], v[208:211], v[40:43], v[240:243]
    v_mfma_f32_16x16x32_bf16 v[228:231], v[196:199], v[40:43], v[228:231]
    v_mfma_f32_16x16x32_bf16 v[244:247], v[212:215], v[40:43], v[244:247]
    v_mfma_f32_16x16x32_bf16 v[232:235], v[200:203], v[40:43], v[232:235]
    v_mfma_f32_16x16x32_bf16 v[248:251], v[216:219], v[40:43], v[248:251]
    v_mfma_f32_16x16x32_bf16 v[236:239], v[204:207], v[40:43], v[236:239]
    v_mfma_f32_16x16x32_bf16 v[252:255], v[220:223], v[40:43], v[252:255]
    s_barrier
    s_and_b32 s63, s3, 3
    s_lshl_b32 s63, s63, 5
    s_lshr_b32 s62, s3, 2
    s_lshl_b32 s62, s62, 15
    s_add_u32 s63, s63, s62
    s_add_u32 s63, s63, 33792
    v_lshrrev_b32 v112, 2, v3
    v_lshl_add_u32 v112, v2, 3, v112
    v_lshlrev_b32 v112, 7, v112
    v_and_b32 v10, 3, v3
    v_lshl_add_u32 v112, v10, 3, v112
    v_add_u32 v112, s63, v112
    s_add_u32 s12, s100, 0
    s_cmp_ge_u32 s12, 7
    s_cselect_b32 s63, 7, 0
    s_sub_u32 s12, s12, s63
    s_add_u32 s12, s12, s85
    s_add_u32 s13, s100, 1
    s_cmp_ge_u32 s13, 7
    s_cselect_b32 s63, 7, 0
    s_sub_u32 s13, s13, s63
    s_add_u32 s13, s13, s85
    s_add_u32 s14, s100, 3
    s_cmp_ge_u32 s14, 7
    s_cselect_b32 s63, 7, 0
    s_sub_u32 s14, s14, s63
    s_add_u32 s14, s14, s85
    s_add_u32 s15, s100, 4
    s_cmp_ge_u32 s15, 7
    s_cselect_b32 s63, 7, 0
    s_sub_u32 s15, s15, s63
    s_add_u32 s15, s15, s85
    s_lshl_b32 s5, s12, 7
    s_add_u32 s5, s5, s51
    s_lshl_b32 s4, s13, 7
    s_add_u32 s4, s4, s51
    s_lshl_b32 s7, s14, 7
    s_add_u32 s7, s7, s51
    s_lshl_b32 s6, s15, 7
    s_add_u32 s6, s6, s51
    s_cmp_ge_u32 s3, 4
    s_cselect_b32 s100, s14, s12
    s_cselect_b32 s101, s15, s13
    v_mov_b32 v121, 137984
    v_mov_b32 v122, 0
    ds_write_b32 v121, v122
    ds_write_b32 v121, v122 offset:4
    ds_write_b32 v121, v122 offset:8
    s_and_b32 s63, s3, 3
    s_lshl_b32 s63, s63, 2
    s_add_u32 s63, s63, 138000
    v_mov_b32 v123, s63
    ds_write_b32 v123, v122
    v_mov_b32 v122, 1
    v_mov_b32 v125, v4
    v_lshlrev_b32 v4, 4, v1
    v_add_u32 v113, s61, v4
    v_lshlrev_b32 v114, 3, v0
    v_lshlrev_b32 v115, 12, v2
    v_lshl_add_u32 v115, v3, 4, v115
    s_lshl_b32 s63, s3, 8
    s_add_u32 s63, s63, 136704
    v_lshlrev_b32 v116, 4, v3
    v_lshl_add_u32 v116, v2, 2, v116
    v_add_u32 v116, s63, v116
    v_and_b32 v117, 3, v3
    v_lshlrev_b32 v117, 8, v117
    v_lshrrev_b32 v10, 3, v3
    v_lshl_add_u32 v117, v10, 7, v117
    v_lshl_add_u32 v117, v2, 5, v117
    v_add_u32 v117, 136704, v117
    s_lshl_b32 s88, s58, 18
    s_lshl_b32 s63, s3, 16
    s_add_u32 s88, s88, s63
    s_add_u32 s88, s88, s54
    s_add_u32 s88, s88, 196608
    s_add_u32 s89, s88, 0x4000
    s_add_u32 s90, s88, 0x8000
    s_add_u32 s91, s88, 0xc000
    s_lshl_b32 s84, s2, 12
    s_add_u32 s84, s84, 196608
    v_cmp_eq_u32 s[50:51], 0, v3
    v_perm_b32 v192, v132, v128, s55
    v_perm_b32 v196, v132, v128, s56
    v_perm_b32 v200, v133, v129, s55
    v_perm_b32 v204, v133, v129, s56
    v_perm_b32 v208, v134, v130, s55
    v_perm_b32 v212, v134, v130, s56
    v_perm_b32 v216, v135, v131, s55
    v_perm_b32 v220, v135, v131, s56
    v_perm_b32 v193, v140, v136, s55
    v_perm_b32 v197, v140, v136, s56
    v_perm_b32 v201, v141, v137, s55
    v_perm_b32 v205, v141, v137, s56
    v_perm_b32 v209, v142, v138, s55
    v_perm_b32 v213, v142, v138, s56
    v_perm_b32 v217, v143, v139, s55
    v_perm_b32 v221, v143, v139, s56
    s_barrier
    s_waitcnt vmcnt(7)
    s_add_u32 s97, s48, 229376
    buffer_load_dwordx4 v[176:179], v6, s[8:11], s97 offen offset:0 nt
    s_waitcnt vmcnt(7)
    buffer_load_dwordx4 v[180:183], v6, s[8:11], s97 offen offset:1024 nt
    v_perm_b32 v194, v148, v144, s55
    v_perm_b32 v198, v148, v144, s56
    v_perm_b32 v202, v149, v145, s55
    v_perm_b32 v206, v149, v145, s56
    v_perm_b32 v210, v150, v146, s55
    v_perm_b32 v214, v150, v146, s56
    v_perm_b32 v218, v151, v147, s55
    v_perm_b32 v222, v151, v147, s56
    s_barrier
    s_waitcnt vmcnt(7)
    buffer_load_dwordx4 v[184:187], v6, s[8:11], s97 offen offset:2048 nt
    s_waitcnt vmcnt(7)
    buffer_load_dwordx4 v[188:191], v6, s[8:11], s97 offen offset:3072 nt
    v_perm_b32 v195, v156, v152, s55
    v_perm_b32 v199, v156, v152, s56
    v_perm_b32 v203, v157, v153, s55
    v_perm_b32 v207, v157, v153, s56
    v_perm_b32 v211, v158, v154, s55
    v_perm_b32 v215, v158, v154, s56
    v_perm_b32 v219, v159, v155, s55
    v_perm_b32 v223, v159, v155, s56
    v_mfma_f32_16x16x32_bf16 v[224:227], v[192:195], v[48:51], v[224:227]
    v_mfma_f32_16x16x32_bf16 v[240:243], v[208:211], v[48:51], v[240:243]
    v_mfma_f32_16x16x32_bf16 v[228:231], v[196:199], v[48:51], v[228:231]
    v_mfma_f32_16x16x32_bf16 v[244:247], v[212:215], v[48:51], v[244:247]
    v_mfma_f32_16x16x32_bf16 v[232:235], v[200:203], v[48:51], v[232:235]
    v_mfma_f32_16x16x32_bf16 v[248:251], v[216:219], v[48:51], v[248:251]
    v_mfma_f32_16x16x32_bf16 v[236:239], v[204:207], v[48:51], v[236:239]
    v_mfma_f32_16x16x32_bf16 v[252:255], v[220:223], v[48:51], v[252:255]
    s_barrier
    s_waitcnt vmcnt(7)
    s_add_u32 s49, s53, 0
    s_add_u32 m0, s99, 99328
    s_nop 0
    buffer_load_dwordx4 v7, s[16:19], s49 offen nt lds
    s_waitcnt vmcnt(7)
    s_add_u32 s49, s53, 32768
    s_add_u32 m0, s99, 100384
    s_nop 0
    buffer_load_dwordx4 v7, s[16:19], s49 offen nt lds
    v_perm_b32 v192, v164, v160, s55
    v_perm_b32 v196, v164, v160, s56
    v_perm_b32 v200, v165, v161, s55
    v_perm_b32 v204, v165, v161, s56
    v_perm_b32 v208, v166, v162, s55
    v_perm_b32 v212, v166, v162, s56
    v_perm_b32 v216, v167, v163, s55
    v_perm_b32 v220, v167, v163, s56
    s_barrier
    s_waitcnt vmcnt(7)
    s_add_u32 s49, s53, 262144
    s_add_u32 m0, s99, 101440
    s_nop 0
    buffer_load_dwordx4 v7, s[16:19], s49 offen nt lds
    s_waitcnt vmcnt(7)
    s_add_u32 s49, s53, 294912
    s_add_u32 m0, s99, 102496
    s_nop 0
    buffer_load_dwordx4 v7, s[16:19], s49 offen nt lds
    v_perm_b32 v193, v172, v168, s55
    v_perm_b32 v197, v172, v168, s56
    v_perm_b32 v201, v173, v169, s55
    v_perm_b32 v205, v173, v169, s56
    v_perm_b32 v209, v174, v170, s55
    v_perm_b32 v213, v174, v170, s56
    v_perm_b32 v217, v175, v171, s55
    v_perm_b32 v221, v175, v171, s56
    s_waitcnt vmcnt(6)
    v_perm_b32 v194, v180, v176, s55
    v_perm_b32 v198, v180, v176, s56
    v_perm_b32 v202, v181, v177, s55
    v_perm_b32 v206, v181, v177, s56
    v_perm_b32 v210, v182, v178, s55
    v_perm_b32 v214, v182, v178, s56
    v_perm_b32 v218, v183, v179, s55
    v_perm_b32 v222, v183, v179, s56
    s_waitcnt vmcnt(4)
    v_perm_b32 v195, v188, v184, s55
    v_perm_b32 v199, v188, v184, s56
    v_perm_b32 v203, v189, v185, s55
    v_perm_b32 v207, v189, v185, s56
    v_perm_b32 v211, v190, v186, s55
    v_perm_b32 v215, v190, v186, s56
    v_perm_b32 v219, v191, v187, s55
    v_perm_b32 v223, v191, v187, s56
    v_mfma_f32_16x16x32_bf16 v[224:227], v[192:195], v[56:59], v[224:227]
    v_mfma_f32_16x16x32_bf16 v[240:243], v[208:211], v[56:59], v[240:243]
    v_mfma_f32_16x16x32_bf16 v[228:231], v[196:199], v[56:59], v[228:231]
    v_mfma_f32_16x16x32_bf16 v[244:247], v[212:215], v[56:59], v[244:247]
    v_mfma_f32_16x16x32_bf16 v[232:235], v[200:203], v[56:59], v[232:235]
    v_mfma_f32_16x16x32_bf16 v[248:251], v[216:219], v[56:59], v[248:251]
    v_mfma_f32_16x16x32_bf16 v[236:239], v[204:207], v[56:59], v[236:239]
    v_mfma_f32_16x16x32_bf16 v[252:255], v[220:223], v[56:59], v[252:255]
    s_nop 1
    v_mov_b32 v224, v240 row_shr:8 row_mask:0xf bank_mask:0xc
    v_mov_b32 v225, v241 row_shr:8 row_mask:0xf bank_mask:0xc
    v_mov_b32 v226, v242 row_shr:8 row_mask:0xf bank_mask:0xc
    v_mov_b32 v227, v243 row_shr:8 row_mask:0xf bank_mask:0xc
    ds_write_b128 v113, v[224:227] offset:0
    v_mov_b32 v228, v244 row_shr:8 row_mask:0xf bank_mask:0xc
    v_mov_b32 v229, v245 row_shr:8 row_mask:0xf bank_mask:0xc
    v_mov_b32 v230, v246 row_shr:8 row_mask:0xf bank_mask:0xc
    v_mov_b32 v231, v247 row_shr:8 row_mask:0xf bank_mask:0xc
    ds_write_b128 v113, v[228:231] offset:1024
    v_mov_b32 v232, v248 row_shr:8 row_mask:0xf bank_mask:0xc
    v_mov_b32 v233, v249 row_shr:8 row_mask:0xf bank_mask:0xc
    v_mov_b32 v234, v250 row_shr:8 row_mask:0xf bank_mask:0xc
    v_mov_b32 v235, v251 row_shr:8 row_mask:0xf bank_mask:0xc
    ds_write_b128 v113, v[232:235] offset:2048
    v_mov_b32 v236, v252 row_shr:8 row_mask:0xf bank_mask:0xc
    v_mov_b32 v237, v253 row_shr:8 row_mask:0xf bank_mask:0xc
    v_mov_b32 v238, v254 row_shr:8 row_mask:0xf bank_mask:0xc
    v_mov_b32 v239, v255 row_shr:8 row_mask:0xf bank_mask:0xc
    ds_write_b128 v113, v[236:239] offset:3072
    s_waitcnt lgkmcnt(0)
    s_barrier
    ds_read_b64 v[128:129], v114 offset:0
    ds_read_b64 v[130:131], v114 offset:4096
    ds_read_b64 v[132:133], v114 offset:8192
    ds_read_b64 v[134:135], v114 offset:12288
    ds_read_b64 v[136:137], v114 offset:16384
    ds_read_b64 v[138:139], v114 offset:20480
    ds_read_b64 v[140:141], v114 offset:24576
    ds_read_b64 v[142:143], v114 offset:28672
    s_waitcnt lgkmcnt(4)
    v_pk_add_f32 v[128:129], v[128:129], v[130:131]
    v_pk_add_f32 v[132:133], v[132:133], v[134:135]
    v_pk_add_f32 v[128:129], v[128:129], v[132:133]
    s_waitcnt lgkmcnt(0)
    v_pk_add_f32 v[136:137], v[136:137], v[138:139]
    v_pk_add_f32 v[140:141], v[140:141], v[142:143]
    v_pk_add_f32 v[136:137], v[136:137], v[140:141]
    v_pk_add_f32 v[128:129], v[128:129], v[136:137]
    v_min_u32 v128, -2, v128
    v_min_u32 v129, -2, v129
    buffer_store_dwordx2 v[128:129], v114, s[36:39], s84 offen sc1
    s_cmp_ge_u32 s3, 4
    s_cbranch_scc1 L_s2_opp
    s_sleep 14
    s_mov_b32 s62, 131072
L_e1:
    buffer_load_dwordx4 v[176:179], v115, s[36:39], s88 offen sc1
    buffer_load_dwordx4 v[180:183], v115, s[36:39], s89 offen sc1
    buffer_load_dwordx4 v[184:187], v115, s[36:39], s90 offen sc1
    buffer_load_dwordx4 v[188:191], v115, s[36:39], s91 offen sc1
    s_waitcnt vmcnt(0)
    v_max_u32 v9, v176, v177
    v_max_u32 v8, v178, v179
    v_max3_u32 v9, v9, v180, v181
    v_max3_u32 v8, v8, v182, v183
    v_max3_u32 v9, v9, v184, v185
    v_max3_u32 v8, v8, v186, v187
    v_max3_u32 v9, v9, v188, v189
    v_max3_u32 v8, v8, v190, v191
    v_max_u32 v9, v9, v8
    v_cmp_eq_u32 vcc, -1, v9
    s_cbranch_vccz L_e1_ok
    s_sub_u32 s62, s62, 1
    s_cbranch_scc0 L_e1
L_e1_ok:
    v_pk_add_f32 v[128:129], v[176:177], v[180:181]
    v_pk_add_f32 v[130:131], v[178:179], v[182:183]
    v_pk_add_f32 v[132:133], v[184:185], v[188:189]
    v_pk_add_f32 v[134:135], v[186:187], v[190:191]
    v_pk_add_f32 v[128:129], v[128:129], v[132:133]
    v_pk_add_f32 v[130:131], v[130:131], v[134:135]
    s_nop 1
    v_permlane32_swap_b32 v128, v130
    v_permlane32_swap_b32 v129, v131
    v_add_f32 v128, v128, v130
    v_add_f32 v129, v129, v131
    s_nop 1
    v_permlane16_swap_b32 v128, v129
    v_add_f32 v128, v128, v129
    ds_write_b32 v116, v128
    s_branch L_s2_skip
L_s2_opp:
    s_waitcnt vmcnt(0)
L_s2_skip:
    s_waitcnt lgkmcnt(0)
    s_barrier
    ds_read_b128 v[128:131], v117
    ds_read_b128 v[132:135], v117 offset:16
    ds_read_b64_tr_b16 v[36:37], v11 offset:0
    ds_read_b64_tr_b16 v[38:39], v11 offset:2112
    ds_read_b64_tr_b16 v[44:45], v11 offset:16896
    ds_read_b64_tr_b16 v[46:47], v11 offset:19008
    ds_read_b64_tr_b16 v[52:53], v11 offset:32
    ds_read_b64_tr_b16 v[54:55], v11 offset:2144
    ds_read_b64_tr_b16 v[60:61], v11 offset:16928
    ds_read_b64_tr_b16 v[62:63], v11 offset:19040
    s_cmp_lt_u32 s3, 4
    s_cbranch_scc1 L_hs_skip
    s_add_u32 s49, s4, 0
    s_add_u32 m0, s61, 33792
    s_nop 0
    buffer_load_dwordx4 v8, s[20:23], s49 offen nt lds
    s_sub_u32 s49, s7, 917504
    s_add_u32 m0, s61, 50176
    s_nop 0
    buffer_load_dwordx4 v8, s[24:27], s49 offen nt lds
    s_add_u32 s49, s6, 0
    s_add_u32 m0, s61, 66560
    s_nop 0
    buffer_load_dwordx4 v8, s[24:27], s49 offen nt lds
    s_sub_u32 s49, s5, 917504
    s_add_u32 m0, s61, 17408
    s_nop 0
    buffer_load_dwordx4 v8, s[20:23], s49 offen nt lds
L_hs_skip:
    s_waitcnt lgkmcnt(9)
    v_add_f32 v128, v128, v128 quad_perm:[1,0,3,2] row_mask:0xf bank_mask:0xf
    v_add_f32 v129, v129, v129 quad_perm:[1,0,3,2] row_mask:0xf bank_mask:0xf
    v_add_f32 v130, v130, v130 quad_perm:[1,0,3,2] row_mask:0xf bank_mask:0xf
    v_add_f32 v131, v131, v131 quad_perm:[1,0,3,2] row_mask:0xf bank_mask:0xf
    s_waitcnt lgkmcnt(8)
    v_add_f32 v132, v132, v132 quad_perm:[1,0,3,2] row_mask:0xf bank_mask:0xf
    v_add_f32 v133, v133, v133 quad_perm:[1,0,3,2] row_mask:0xf bank_mask:0xf
    v_add_f32 v134, v134, v134 quad_perm:[1,0,3,2] row_mask:0xf bank_mask:0xf
    v_add_f32 v135, v135, v135 quad_perm:[1,0,3,2] row_mask:0xf bank_mask:0xf
    v_add_f32 v128, v128, v128 quad_perm:[2,3,0,1] row_mask:0xf bank_mask:0xf
    v_add_f32 v129, v129, v129 quad_perm:[2,3,0,1] row_mask:0xf bank_mask:0xf
    v_add_f32 v130, v130, v130 quad_perm:[2,3,0,1] row_mask:0xf bank_mask:0xf
    v_add_f32 v131, v131, v131 quad_perm:[2,3,0,1] row_mask:0xf bank_mask:0xf
    v_add_f32 v132, v132, v132 quad_perm:[2,3,0,1] row_mask:0xf bank_mask:0xf
    v_add_f32 v133, v133, v133 quad_perm:[2,3,0,1] row_mask:0xf bank_mask:0xf
    v_add_f32 v134, v134, v134 quad_perm:[2,3,0,1] row_mask:0xf bank_mask:0xf
    v_add_f32 v135, v135, v135 quad_perm:[2,3,0,1] row_mask:0xf bank_mask:0xf
    v_cvt_pk_bf16_f32 v16, v128, v129
    v_cvt_pk_bf16_f32 v17, v130, v131
    v_cvt_pk_bf16_f32 v18, v132, v133
    v_cvt_pk_bf16_f32 v19, v134, v135
    v_mov_b32 v20, v16 row_ror:8 row_mask:0xf bank_mask:0xf
    v_mov_b32 v21, v17 row_ror:8 row_mask:0xf bank_mask:0xf
    v_mov_b32 v22, v18 row_ror:8 row_mask:0xf bank_mask:0xf
    v_mov_b32 v23, v19 row_ror:8 row_mask:0xf bank_mask:0xf
    s_waitcnt lgkmcnt(0)
    v_mfma_f32_16x16x32_bf16 v[128:131], v[36:39], v[16:19], 0
    v_mfma_f32_16x16x32_bf16 v[132:135], v[52:55], v[16:19], 0
    v_mfma_f32_16x16x32_bf16 v[128:131], v[44:47], v[20:23], v[128:131]
    v_mfma_f32_16x16x32_bf16 v[132:135], v[60:63], v[20:23], v[132:135]
    s_nop 7
    v_cndmask_b32 v136, v132, v128, s[50:51]
    v_cndmask_b32 v137, v133, v129, s[50:51]
    v_cndmask_b32 v138, v134, v130, s[50:51]
    v_cndmask_b32 v139, v135, v131, s[50:51]
    v_and_or_b32 v136, v136, -4, 2
    v_and_or_b32 v137, v137, -4, 2
    v_and_or_b32 v138, v138, -4, 2
    v_and_or_b32 v139, v139, -4, 2
    buffer_store_dwordx4 v[136:139], v14, s[36:39], s92 offen sc1
    s_cmp_ge_u32 s2, 224
    s_cbranch_scc1 L_reducer
    s_and_b32 s63, s3, 4
    s_add_u32 s63, s63, s60
    s_lshl_b32 s63, s63, 9
    s_and_b32 s62, s3, 3
    s_lshl_b32 s62, s62, 6
    s_add_u32 s63, s63, s62
    s_lshl_b32 s88, s100, 12
    s_add_u32 s88, s88, s63
    s_lshl_b32 s90, s101, 12
    s_add_u32 s90, s90, s63
    s_add_u32 s90, s90, 256
    s_add_u32 s89, s88, 1777664
    s_add_u32 s88, s88, 1548288
    s_add_u32 s13, s90, 1777664
    s_add_u32 s12, s90, 1548288
    s_lshl_b32 s84, s93, 12
    s_add_u32 s85, s84, 1548288
    s_add_u32 s84, s84, 1777664
    v_lshlrev_b32 v116, 4, v2
    v_add_u32 v117, 137728, v116
    v_add_u32 v116, 133120, v116
    s_cmp_lg_u32 s3, 0
    s_cbranch_scc1 L_s4_ld
    v_lshrrev_b32 v11, 3, v1
    v_lshlrev_b32 v11, 7, v11
    v_and_b32 v9, 7, v1
    v_lshl_add_u32 v11, v9, 3, v11
    v_lshrrev_b32 v10, 2, v1
    v_lshlrev_b32 v10, 7, v10
    v_and_b32 v9, 3, v1
    v_lshl_add_u32 v10, v9, 4, v10
    s_lshl_b32 s63, s60, 10
    s_xor_b32 s48, s63, 0x400
    s_and_b32 s49, s63, 0x800
    s_xor_b32 s49, s49, 0x800
    s_add_u32 s63, s63, 1540096
    s_add_u32 s48, s48, 1540096
    s_add_u32 s49, s49, 1540096
    v_lshlrev_b32 v118, 3, v1
    v_add_u32 v118, 133120, v118
    v_lshlrev_b32 v119, 3, v3
    v_lshl_add_u32 v119, v2, 1, v119
    v_add_u32 v119, 137728, v119
    v_mov_b32 v120, 0x3d372713
    s_mov_b32 s62, 0x20000
    s_mov_b32 s53, 0
L_lsync0:
    s_sleep 1
    ds_read_b32 v123, v121 offset:0
    s_waitcnt lgkmcnt(0)
    v_cmp_gt_u32 vcc, 4, v123
    s_cbranch_vccnz L_lsync0
L_e2b:
    buffer_load_dwordx2 v[176:177], v11, s[36:39], s63 offen sc1
    buffer_load_dwordx2 v[178:179], v11, s[36:39], s48 offen sc1
    buffer_load_dwordx4 v[180:183], v10, s[36:39], s49 offen sc1
    ds_write_b32 v121, v122 offset:4
    s_cmp_lg_u32 s53, 0
    s_cbranch_scc1 L_e2b_w
    ds_read_b32 v123, v121
    s_waitcnt lgkmcnt(0)
    v_cmp_gt_u32 vcc, 4, v123
    s_cbranch_vccnz L_e2b_w
    ds_read_b64_tr_b16 v[64:65], v112 offset:0
    ds_read_b64_tr_b16 v[66:67], v112 offset:512
    ds_read_b64_tr_b16 v[68:69], v112 offset:4096
    ds_read_b64_tr_b16 v[70:71], v112 offset:4608
    ds_read_b64_tr_b16 v[72:73], v112 offset:8192
    ds_read_b64_tr_b16 v[74:75], v112 offset:8704
    ds_read_b64_tr_b16 v[76:77], v112 offset:12288
    ds_read_b64_tr_b16 v[78:79], v112 offset:12800
    ds_read_b64_tr_b16 v[80:81], v112 offset:16384
    ds_read_b64_tr_b16 v[82:83], v112 offset:16896
    ds_read_b64_tr_b16 v[84:85], v112 offset:20480
    ds_read_b64_tr_b16 v[86:87], v112 offset:20992
    ds_read_b64_tr_b16 v[88:89], v112 offset:24576
    ds_read_b64_tr_b16 v[90:91], v112 offset:25088
    ds_read_b64_tr_b16 v[92:93], v112 offset:28672
    ds_read_b64_tr_b16 v[94:95], v112 offset:29184
    s_mov_b32 s53, 1
L_e2b_w:
    s_waitcnt vmcnt(0)
    v_max_u32 v9, v176, v177
    v_max_u32 v8, v178, v179
    v_max3_u32 v9, v9, v180, v181
    v_max3_u32 v8, v8, v182, v183
    v_max_u32 v9, v9, v8
    v_cmp_eq_u32 vcc, -1, v9
    s_cbranch_vccz L_e2b_ok
    s_sub_u32 s62, s62, 1
    s_cbranch_scc0 L_e2b
L_e2b_ok:
    ds_write_b32 v121, v122 offset:4
    v_dot2_f32_bf16 v16, v176, s57, 0
    v_dot2_f32_bf16 v17, v176, v176, 0
    v_dot2_f32_bf16 v16, v177, s57, v16
    v_dot2_f32_bf16 v17, v177, v177, v17
    v_dot2_f32_bf16 v16, v178, s57, v16
    v_dot2_f32_bf16 v17, v178, v178, v17
    v_dot2_f32_bf16 v16, v179, s57, v16
    v_dot2_f32_bf16 v17, v179, v179, v17
    v_dot2_f32_bf16 v16, v180, s57, v16
    v_dot2_f32_bf16 v17, v180, v180, v17
    v_dot2_f32_bf16 v16, v181, s57, v16
    v_dot2_f32_bf16 v17, v181, v181, v17
    v_dot2_f32_bf16 v16, v182, s57, v16
    v_dot2_f32_bf16 v17, v182, v182, v17
    v_dot2_f32_bf16 v16, v183, s57, v16
    v_dot2_f32_bf16 v17, v183, v183, v17
    v_lshlrev_b32 v20, 16, v176
    v_and_b32 v21, s94, v176
    v_lshlrev_b32 v22, 16, v177
    v_and_b32 v23, s94, v177
    v_add_f32 v16, v16, v16 row_shr:1 row_mask:0xf bank_mask:0xf bound_ctrl:0
    v_add_f32 v17, v17, v17 row_shr:1 row_mask:0xf bank_mask:0xf bound_ctrl:0
    s_nop 0
    v_add_f32 v16, v16, v16 row_shr:2 row_mask:0xf bank_mask:0xf bound_ctrl:0
    v_add_f32 v17, v17, v17 row_shr:2 row_mask:0xf bank_mask:0xf bound_ctrl:0
    s_nop 0
    v_add_f32 v16, v16, v16 row_shr:4 row_mask:0xf bank_mask:0xf bound_ctrl:0
    v_add_f32 v17, v17, v17 row_shr:4 row_mask:0xf bank_mask:0xf bound_ctrl:0
    s_nop 0
    v_add_f32 v16, v16, v16 row_shr:8 row_mask:0xf bank_mask:0xf bound_ctrl:0
    v_add_f32 v17, v17, v17 row_shr:8 row_mask:0xf bank_mask:0xf bound_ctrl:0
    s_nop 0
    v_add_f32 v16, v16, v16 row_bcast:15 row_mask:0xa bank_mask:0xf
    v_add_f32 v17, v17, v17 row_bcast:15 row_mask:0xa bank_mask:0xf
    s_nop 0
    v_add_f32 v16, v16, v16 row_bcast:31 row_mask:0xc bank_mask:0xf
    v_add_f32 v17, v17, v17 row_bcast:31 row_mask:0xc bank_mask:0xf
    v_mov_b32 v19, 0x3a800000
    v_readlane_b32 s90, v16, 63
    v_readlane_b32 s91, v17, 63
    s_nop 0
    v_mul_f32 v18, s90, v19
    v_mul_f32 v19, s91, v19
    v_fma_f32 v19, -v18, v18, v19
    v_max_f32 v19, 0, v19
    v_cvt_pk_bf16_f32 v19, v18, v19
    v_lshlrev_b32 v18, 16, v19
    v_and_b32 v19, s94, v19
    v_add_f32 v19, 0x3727c5ac, v19
    v_cvt_pk_bf16_f32 v19, v19, v19
    v_and_b32 v19, s94, v19
    v_sqrt_f32 v19, v19
    v_sub_f32 v20, v20, v18
    v_sub_f32 v21, v21, v18
    v_sub_f32 v22, v22, v18
    v_sub_f32 v23, v23, v18
    v_cvt_pk_bf16_f32 v19, v19, v19
    v_and_b32 v19, s94, v19
    v_rcp_f32 v19, v19
    v_cvt_pk_bf16_f32 v16, v20, v21
    v_cvt_pk_bf16_f32 v17, v22, v23
    v_lshlrev_b32 v20, 16, v16
    v_and_b32 v21, s94, v16
    v_lshlrev_b32 v22, 16, v17
    v_and_b32 v23, s94, v17
    v_mul_f32 v20, v20, v19
    v_mul_f32 v21, v21, v19
    v_mul_f32 v22, v22, v19
    v_mul_f32 v23, v23, v19
    v_cvt_pk_bf16_f32 v16, v20, v21
    v_cvt_pk_bf16_f32 v17, v22, v23
    ds_write_b64 v118, v[16:17]
    s_cmp_lg_u32 s53, 0
    s_cbranch_scc1 L_s4_skip
    s_branch L_s4_pq
L_s4_ld:
    s_cmp_lt_u32 s3, 4
    s_cbranch_scc1 L_s4_pp
    v_lshrrev_b32 v7, 5, v1
    v_lshlrev_b32 v7, 11, v7
    v_and_b32 v11, 31, v1
    v_lshl_add_u32 v7, v11, 4, v7
    s_waitcnt vmcnt(6)
    s_add_u32 s49, s4, 57344
    s_add_u32 m0, s61, 34816
    s_nop 0
    buffer_load_dwordx4 v8, s[20:23], s49 offen nt lds
    s_waitcnt vmcnt(6)
    s_sub_u32 s49, s7, 860160
    s_add_u32 m0, s61, 51200
    s_nop 0
    buffer_load_dwordx4 v8, s[24:27], s49 offen nt lds
    s_waitcnt vmcnt(6)
    s_add_u32 s49, s6, 57344
    s_add_u32 m0, s61, 67584
    s_nop 0
    buffer_load_dwordx4 v8, s[24:27], s49 offen nt lds
    s_waitcnt vmcnt(6)
    s_sub_u32 s49, s5, 860160
    s_add_u32 m0, s61, 18432
    s_nop 0
    buffer_load_dwordx4 v8, s[20:23], s49 offen nt lds
    s_waitcnt vmcnt(6)
    s_add_u32 s49, s4, 114688
    s_add_u32 m0, s61, 35840
    s_nop 0
    buffer_load_dwordx4 v8, s[20:23], s49 offen nt lds
    s_waitcnt vmcnt(6)
    s_sub_u32 s49, s7, 802816
    s_add_u32 m0, s61, 52224
    s_nop 0
    buffer_load_dwordx4 v8, s[24:27], s49 offen nt lds
    s_waitcnt vmcnt(6)
    s_add_u32 s49, s6, 114688
    s_add_u32 m0, s61, 68608
    s_nop 0
    buffer_load_dwordx4 v8, s[24:27], s49 offen nt lds
    s_waitcnt vmcnt(6)
    s_sub_u32 s49, s5, 802816
    s_add_u32 m0, s61, 19456
    s_nop 0
    buffer_load_dwordx4 v8, s[20:23], s49 offen nt lds
    s_waitcnt vmcnt(6)
    s_add_u32 s49, s4, 172032
    s_add_u32 m0, s61, 36864
    s_nop 0
    buffer_load_dwordx4 v8, s[20:23], s49 offen nt lds
    s_waitcnt vmcnt(6)
    s_sub_u32 s49, s7, 745472
    s_add_u32 m0, s61, 53248
    s_nop 0
    buffer_load_dwordx4 v8, s[24:27], s49 offen nt lds
    s_waitcnt vmcnt(6)
    s_add_u32 s49, s6, 172032
    s_add_u32 m0, s61, 69632
    s_nop 0
    buffer_load_dwordx4 v8, s[24:27], s49 offen nt lds
    s_waitcnt vmcnt(6)
    s_sub_u32 s49, s5, 745472
    s_add_u32 m0, s61, 20480
    s_nop 0
    buffer_load_dwordx4 v8, s[20:23], s49 offen nt lds
    s_waitcnt vmcnt(6)
    s_add_u32 s49, s52, 0
    s_add_u32 m0, s99, 0
    s_nop 0
    buffer_load_dwordx4 v7, s[28:31], s49 offen nt lds
    s_waitcnt vmcnt(6)
    s_add_u32 s49, s52, 4096
    s_add_u32 m0, s99, 1056
    s_nop 0
    buffer_load_dwordx4 v7, s[28:31], s49 offen nt lds
    s_waitcnt vmcnt(6)
    s_add_u32 s49, s52, 8192
    s_add_u32 m0, s99, 2112
    s_nop 0
    buffer_load_dwordx4 v7, s[28:31], s49 offen nt lds
    s_waitcnt vmcnt(3)
    s_mov_b64 exec, 1
    ds_add_u32 v121, v122
    s_mov_b64 exec, -1
L_fwait:
    ds_read_b32 v123, v121 offset:4
    s_waitcnt lgkmcnt(0)
    v_cmp_gt_u32 vcc, 1, v123
    s_cbranch_vccnz L_fwait
    s_add_u32 s49, s52, 12288
    s_add_u32 m0, s99, 3168
    s_nop 0
    buffer_load_dwordx4 v7, s[28:31], s49 offen nt lds
    s_sub_u32 s49, s52, 65536
    s_sub_u32 m0, s99, 16896
    s_nop 0
    buffer_load_dwordx4 v7, s[28:31], s49 offen nt lds
    s_sub_u32 s49, s52, 61440
    s_sub_u32 m0, s99, 15840
    s_nop 0
    buffer_load_dwordx4 v7, s[28:31], s49 offen nt lds
    s_sub_u32 s49, s52, 57344
    s_sub_u32 m0, s99, 14784
    s_nop 0
    buffer_load_dwordx4 v7, s[28:31], s49 offen nt lds
    s_sub_u32 s49, s52, 53248
    s_sub_u32 m0, s99, 13728
    s_nop 0
    buffer_load_dwordx4 v7, s[28:31], s49 offen nt lds
    s_branch L_s4_pq
L_s4_pp:
    s_cmp_lg_u32 s3, 1
    s_cbranch_scc1 L_s4_pq
    buffer_load_dwordx4 v[176:179], v4, s[36:39], s84 offen offset:0 sc1
    buffer_load_dwordx4 v[180:183], v4, s[36:39], s84 offen offset:1024 sc1
    buffer_load_dwordx4 v[184:187], v4, s[36:39], s84 offen offset:2048 sc1
    buffer_load_dwordx4 v[188:191], v4, s[36:39], s84 offen offset:3072 sc1
L_s4_pq:
L_lsync1:
    ds_read_b32 v123, v121
    s_waitcnt lgkmcnt(0)
    v_cmp_gt_u32 vcc, 4, v123
    s_cbranch_vccz L_ls1_ok
    s_sleep 2
    s_branch L_lsync1
L_ls1_ok:
    ds_read_b64_tr_b16 v[64:65], v112 offset:0
    ds_read_b64_tr_b16 v[66:67], v112 offset:512
    ds_read_b64_tr_b16 v[68:69], v112 offset:4096
    ds_read_b64_tr_b16 v[70:71], v112 offset:4608
    ds_read_b64_tr_b16 v[72:73], v112 offset:8192
    ds_read_b64_tr_b16 v[74:75], v112 offset:8704
    ds_read_b64_tr_b16 v[76:77], v112 offset:12288
    ds_read_b64_tr_b16 v[78:79], v112 offset:12800
    ds_read_b64_tr_b16 v[80:81], v112 offset:16384
    ds_read_b64_tr_b16 v[82:83], v112 offset:16896
    ds_read_b64_tr_b16 v[84:85], v112 offset:20480
    ds_read_b64_tr_b16 v[86:87], v112 offset:20992
    ds_read_b64_tr_b16 v[88:89], v112 offset:24576
    ds_read_b64_tr_b16 v[90:91], v112 offset:25088
    ds_read_b64_tr_b16 v[92:93], v112 offset:28672
    ds_read_b64_tr_b16 v[94:95], v112 offset:29184
L_s4_skip:
    s_waitcnt lgkmcnt(0)
    s_barrier
    ds_read_b128 v[144:147], v116 offset:0
    ds_read_b128 v[160:163], v116 offset:256
    ds_read_b128 v[148:151], v116 offset:64
    ds_read_b128 v[164:167], v116 offset:320
    ds_read_b128 v[152:155], v116 offset:128
    ds_read_b128 v[168:171], v116 offset:384
    ds_read_b128 v[156:159], v116 offset:192
    ds_read_b128 v[172:175], v116 offset:448
    s_waitcnt lgkmcnt(7)
    v_mfma_f32_16x16x32_bf16 v[16:19], v[64:67], v[144:147], 0
    s_waitcnt lgkmcnt(6)
    v_mfma_f32_16x16x32_bf16 v[20:23], v[80:83], v[160:163], 0
    s_waitcnt lgkmcnt(5)
    v_mfma_f32_16x16x32_bf16 v[16:19], v[68:71], v[148:151], v[16:19]
    s_waitcnt lgkmcnt(4)
    v_mfma_f32_16x16x32_bf16 v[20:23], v[84:87], v[164:167], v[20:23]
    s_waitcnt lgkmcnt(3)
    v_mfma_f32_16x16x32_bf16 v[16:19], v[72:75], v[152:155], v[16:19]
    s_waitcnt lgkmcnt(2)
    v_mfma_f32_16x16x32_bf16 v[20:23], v[88:91], v[168:171], v[20:23]
    s_waitcnt lgkmcnt(1)
    v_mfma_f32_16x16x32_bf16 v[16:19], v[76:79], v[156:159], v[16:19]
    s_waitcnt lgkmcnt(0)
    v_mfma_f32_16x16x32_bf16 v[20:23], v[92:95], v[172:175], v[20:23]
    s_nop 5
    v_min_u32 v24, -2, v16
    v_min_u32 v25, -2, v17
    v_min_u32 v26, -2, v18
    v_min_u32 v27, -2, v19
    v_min_u32 v28, -2, v20
    v_min_u32 v29, -2, v21
    v_min_u32 v30, -2, v22
    v_min_u32 v31, -2, v23
    buffer_store_dwordx4 v[24:27], v13, s[36:39], s89 offen
    buffer_store_dwordx4 v[28:31], v13, s[36:39], s13 offen
    s_cmp_eq_u32 s3, 0
    s_cbranch_scc1 L_e2_w0
    s_cmp_lt_u32 s3, 4
    s_cbranch_scc1 L_e2_nl
    s_waitcnt vmcnt(2)
    s_mov_b64 exec, 1
    ds_add_u32 v121, v122
    s_mov_b64 exec, -1
L_e2_nl:
    buffer_store_dwordx4 v[24:27], v13, s[36:39], s88 offen sc1
    buffer_store_dwordx4 v[28:31], v13, s[36:39], s12 offen sc1
    s_branch L_s4b_skip
L_e2_w0:
    s_mov_b32 s62, 10
L_e2l:
    buffer_load_dwordx4 v[176:179], v4, s[36:39], s84 offen offset:0 sc1
    buffer_load_dwordx4 v[180:183], v4, s[36:39], s84 offen offset:1024 sc1
    buffer_load_dwordx4 v[184:187], v4, s[36:39], s84 offen offset:2048 sc1
    buffer_load_dwordx4 v[188:191], v4, s[36:39], s84 offen offset:3072 sc1
    s_waitcnt vmcnt(0)
    v_max_u32 v9, v176, v177
    v_max_u32 v8, v178, v179
    v_max3_u32 v9, v9, v180, v181
    v_max3_u32 v8, v8, v182, v183
    v_max3_u32 v9, v9, v184, v185
    v_max3_u32 v8, v8, v186, v187
    v_max3_u32 v9, v9, v188, v189
    v_max3_u32 v8, v8, v190, v191
    v_max_u32 v9, v9, v8
    v_cmp_eq_u32 vcc, -1, v9
    s_cbranch_vccz L_e2c_ok
    s_sub_u32 s62, s62, 1
    s_cbranch_scc0 L_e2l
    buffer_store_dwordx4 v[24:27], v13, s[36:39], s88 offen sc1
    buffer_store_dwordx4 v[28:31], v13, s[36:39], s12 offen sc1
    s_mov_b32 s62, 131072
L_e2c:
    buffer_load_dwordx4 v[176:179], v4, s[36:39], s85 offen offset:0 sc1
    buffer_load_dwordx4 v[180:183], v4, s[36:39], s85 offen offset:1024 sc1
    buffer_load_dwordx4 v[184:187], v4, s[36:39], s85 offen offset:2048 sc1
    buffer_load_dwordx4 v[188:191], v4, s[36:39], s85 offen offset:3072 sc1
    s_waitcnt vmcnt(0)
    v_max_u32 v9, v176, v177
    v_max_u32 v8, v178, v179
    v_max3_u32 v9, v9, v180, v181
    v_max3_u32 v8, v8, v182, v183
    v_max3_u32 v9, v9, v184, v185
    v_max3_u32 v8, v8, v186, v187
    v_max3_u32 v9, v9, v188, v189
    v_max3_u32 v8, v8, v190, v191
    v_max_u32 v9, v9, v8
    v_cmp_eq_u32 vcc, -1, v9
    s_cbranch_vccz L_e2c_ok
    s_sub_u32 s62, s62, 1
    s_cbranch_scc0 L_e2c
L_e2c_ok:
    ds_read_b32 v123, v121
    v_pk_add_f32 v[176:177], v[176:177], v[180:181]
    v_pk_add_f32 v[178:179], v[178:179], v[182:183]
    v_pk_add_f32 v[180:181], v[184:185], v[188:189]
    v_pk_add_f32 v[182:183], v[186:187], v[190:191]
    v_permlane32_swap_b32 v176, v178
    v_permlane32_swap_b32 v177, v179
    v_permlane32_swap_b32 v180, v182
    v_permlane32_swap_b32 v181, v183
    v_add_f32 v176, v176, v178
    v_add_f32 v177, v177, v179
    v_add_f32 v180, v180, v182
    v_add_f32 v181, v181, v183
    v_permlane16_swap_b32 v176, v177
    s_nop 0
    v_permlane16_swap_b32 v180, v181
    v_add_f32 v176, v176, v177
    v_add_f32 v180, v180, v181
    s_mov_b32 s53, 0
    s_waitcnt lgkmcnt(0)
    v_cmp_gt_u32 vcc, 8, v123
    s_cbranch_vccnz L_w0_np
    ds_read_b64_tr_b16 v[96:97], v15 offset:0
    ds_read_b64_tr_b16 v[98:99], v15 offset:2112
    ds_read_b64_tr_b16 v[100:101], v15 offset:16896
    ds_read_b64_tr_b16 v[102:103], v15 offset:19008
    ds_read_b64_tr_b16 v[104:105], v15 offset:32
    ds_read_b64_tr_b16 v[106:107], v15 offset:2144
    ds_read_b64_tr_b16 v[108:109], v15 offset:16928
    ds_read_b64_tr_b16 v[110:111], v15 offset:19040
    s_mov_b32 s53, 1
L_w0_np:
    v_cvt_pk_bf16_f32 v16, v176, v180
    v_lshlrev_b32 v22, 16, v16
    v_and_b32 v23, s94, v16
    v_mul_f32 v18, v22, v22
    v_mul_f32 v18, v18, v22
    v_fma_f32 v18, v18, v120, v22
    v_mul_f32 v18, 0xc0135761, v18
    v_exp_f32 v18, v18
    s_nop 0
    v_add_f32 v18, 1.0, v18
    v_rcp_f32 v18, v18
    s_nop 0
    v_mul_f32 v18, v18, v22
    v_cvt_pk_bf16_f32 v18, v18, v18
    v_and_b32 v18, s94, v18
    v_mul_f32 v18, v18, v23
    v_cvt_pk_bf16_f32 v18, v18, v18
    ds_write_b16 v119, v18
    s_cmp_lg_u32 s53, 0
    s_cbranch_scc1 L_s4b_go
L_s4b_skip:
L_lsync2:
    ds_read_b32 v123, v121 offset:0
    s_waitcnt lgkmcnt(0)
    v_cmp_gt_u32 vcc, 8, v123
    s_cbranch_vccnz L_lsync2
    ds_read_b64_tr_b16 v[96:97], v15 offset:0
    ds_read_b64_tr_b16 v[98:99], v15 offset:2112
    ds_read_b64_tr_b16 v[100:101], v15 offset:16896
    ds_read_b64_tr_b16 v[102:103], v15 offset:19008
    ds_read_b64_tr_b16 v[104:105], v15 offset:32
    ds_read_b64_tr_b16 v[106:107], v15 offset:2144
    ds_read_b64_tr_b16 v[108:109], v15 offset:16928
    ds_read_b64_tr_b16 v[110:111], v15 offset:19040
L_s4b_go:
    s_waitcnt lgkmcnt(0)
    s_barrier
    ds_read_b128 v[16:19], v117
    ds_read_b128 v[20:23], v117 offset:64
    s_waitcnt lgkmcnt(0)
    v_mfma_f32_16x16x32_bf16 v[128:131], v[96:99], v[16:19], 0
    v_mfma_f32_16x16x32_bf16 v[132:135], v[104:107], v[16:19], 0
    v_mfma_f32_16x16x32_bf16 v[128:131], v[100:103], v[20:23], v[128:131]
    v_mfma_f32_16x16x32_bf16 v[132:135], v[108:111], v[20:23], v[132:135]
    s_nop 7
    v_cndmask_b32 v136, v132, v128, s[50:51]
    v_cndmask_b32 v137, v133, v129, s[50:51]
    v_cndmask_b32 v138, v134, v130, s[50:51]
    v_cndmask_b32 v139, v135, v131, s[50:51]
    v_and_b32 v136, -3, v136
    v_and_b32 v137, -3, v137
    v_and_b32 v138, -3, v138
    v_and_b32 v139, -3, v139
    buffer_store_dwordx4 v[136:139], v14, s[36:39], s95 offen sc1
    s_cmp_lg_u32 s3, 0
    s_cbranch_scc1 L_fin
    buffer_store_dwordx4 v[24:27], v13, s[36:39], s88 offen sc1
    buffer_store_dwordx4 v[28:31], v13, s[36:39], s12 offen sc1
    s_branch L_fin
L_reducer:
    s_cmp_lg_u32 s3, 0
    s_cbranch_scc1 L_fin
    s_sub_u32 s93, s2, 224
    v_lshrrev_b32 v10, 3, v1
    v_lshlrev_b32 v10, 12, v10
    v_and_b32 v11, 7, v1
    v_lshl_add_u32 v10, v11, 4, v10
    s_lshl_b32 s63, s93, 7
    s_add_u32 s84, s63, 1540096
    s_add_u32 s63, s63, 1245184
    s_lshl_b32 s97, s93, 6
    v_lshlrev_b32 v13, 3, v11
    v_lshl_add_u32 v13, v2, 1, v13
    buffer_load_ushort v14, v13, s[32:35], s97 offen
    v_and_b32 v9, 0x18, v1
    v_cmp_eq_u32 vcc, 0, v9
    s_nop 1
    v_cndmask_b32 v13, v12, v13, vcc
    s_sleep 20
    s_mov_b32 s62, 131072
L_e2a:
    s_add_u32 s49, s63, 0
    buffer_load_dwordx4 v[176:179], v10, s[36:39], s49 offen sc1
    s_add_u32 s49, s63, 32768
    buffer_load_dwordx4 v[180:183], v10, s[36:39], s49 offen sc1
    s_add_u32 s49, s63, 65536
    buffer_load_dwordx4 v[184:187], v10, s[36:39], s49 offen sc1
    s_add_u32 s49, s63, 98304
    buffer_load_dwordx4 v[188:191], v10, s[36:39], s49 offen sc1
    s_add_u32 s49, s63, 131072
    buffer_load_dwordx4 v[192:195], v10, s[36:39], s49 offen sc1
    s_add_u32 s49, s63, 163840
    buffer_load_dwordx4 v[196:199], v10, s[36:39], s49 offen sc1
    s_add_u32 s49, s63, 196608
    buffer_load_dwordx4 v[200:203], v10, s[36:39], s49 offen sc1
    s_add_u32 s49, s63, 229376
    buffer_load_dwordx4 v[204:207], v10, s[36:39], s49 offen sc1
    s_waitcnt vmcnt(0)
    v_or_b32 v9, v176, v177
    v_or_b32 v8, v178, v179
    v_or3_b32 v9, v9, v180, v181
    v_or3_b32 v8, v8, v182, v183
    v_or3_b32 v9, v9, v184, v185
    v_or3_b32 v8, v8, v186, v187
    v_or3_b32 v9, v9, v188, v189
    v_or3_b32 v8, v8, v190, v191
    v_or3_b32 v9, v9, v192, v193
    v_or3_b32 v8, v8, v194, v195
    v_or3_b32 v9, v9, v196, v197
    v_or3_b32 v8, v8, v198, v199
    v_or3_b32 v9, v9, v200, v201
    v_or3_b32 v8, v8, v202, v203
    v_or3_b32 v9, v9, v204, v205
    v_or3_b32 v8, v8, v206, v207
    v_or_b32 v9, v9, v8
    v_and_b32 v9, 1, v9
    v_cmp_ne_u32 vcc, 0, v9
    s_cbranch_vccz L_e2a_ok
    s_sub_u32 s62, s62, 1
    s_cbranch_scc0 L_e2a
L_e2a_ok:
    v_lshlrev_b32 v14, 16, v14
    v_pk_add_f32 v[176:177], v[176:177], v[180:181]
    v_pk_add_f32 v[178:179], v[178:179], v[182:183]
    v_pk_add_f32 v[184:185], v[184:185], v[188:189]
    v_pk_add_f32 v[186:187], v[186:187], v[190:191]
    v_pk_add_f32 v[192:193], v[192:193], v[196:197]
    v_pk_add_f32 v[194:195], v[194:195], v[198:199]
    v_pk_add_f32 v[200:201], v[200:201], v[204:205]
    v_pk_add_f32 v[202:203], v[202:203], v[206:207]
    v_pk_add_f32 v[176:177], v[176:177], v[184:185]
    v_pk_add_f32 v[178:179], v[178:179], v[186:187]
    v_pk_add_f32 v[192:193], v[192:193], v[200:201]
    v_pk_add_f32 v[194:195], v[194:195], v[202:203]
    v_pk_add_f32 v[176:177], v[176:177], v[192:193]
    v_pk_add_f32 v[178:179], v[178:179], v[194:195]
    s_nop 1
    v_permlane32_swap_b32 v176, v178
    v_permlane32_swap_b32 v177, v179
    v_add_f32 v176, v176, v178
    v_add_f32 v177, v177, v179
    s_nop 1
    v_permlane16_swap_b32 v176, v177
    v_add_f32 v176, v176, v177
    s_nop 1
    v_add_f32 v16, v176, v176 row_ror:8 row_mask:0xf bank_mask:0xf
    v_cvt_pk_bf16_f32 v16, v16, v16
    v_and_b32 v16, s94, v16
    v_add_f32 v14, v14, v16
    v_cvt_pk_bf16_f32 v14, v14, v14
    v_and_b32 v14, s94, v14
    v_mov_b32 v16, v14
    v_mov_b32 v17, v14
    s_nop 1
    v_permlane16_swap_b32 v16, v17
    v_perm_b32 v16, v17, v16, s56
    v_min_u32 v16, -2, v16
    buffer_store_dword v16, v13, s[36:39], s84 offen sc1
    s_add_u32 s87, s87, 1
    v_mov_b32 v18, s87
    v_cmp_eq_u32 vcc, 0, v0
    s_nop 1
    v_cndmask_b32 v19, v12, 0, vcc
    s_cmp_eq_u32 s2, 255
    s_cselect_b32 s49, 163840, s38
    buffer_store_dword v18, v19, s[36:39], s49 offen sc1
    s_sleep 90
    s_mov_b32 s62, 131072
L_e3:
    s_add_u32 s49, s63, 0
    buffer_load_dwordx4 v[176:179], v10, s[36:39], s49 offen sc1
    s_add_u32 s49, s63, 32768
    buffer_load_dwordx4 v[180:183], v10, s[36:39], s49 offen sc1
    s_add_u32 s49, s63, 65536
    buffer_load_dwordx4 v[184:187], v10, s[36:39], s49 offen sc1
    s_add_u32 s49, s63, 98304
    buffer_load_dwordx4 v[188:191], v10, s[36:39], s49 offen sc1
    s_add_u32 s49, s63, 131072
    buffer_load_dwordx4 v[192:195], v10, s[36:39], s49 offen sc1
    s_add_u32 s49, s63, 163840
    buffer_load_dwordx4 v[196:199], v10, s[36:39], s49 offen sc1
    s_add_u32 s49, s63, 196608
    buffer_load_dwordx4 v[200:203], v10, s[36:39], s49 offen sc1
    s_waitcnt vmcnt(0)
    v_or_b32 v9, v176, v177
    v_or_b32 v8, v178, v179
    v_or3_b32 v9, v9, v180, v181
    v_or3_b32 v8, v8, v182, v183
    v_or3_b32 v9, v9, v184, v185
    v_or3_b32 v8, v8, v186, v187
    v_or3_b32 v9, v9, v188, v189
    v_or3_b32 v8, v8, v190, v191
    v_or3_b32 v9, v9, v192, v193
    v_or3_b32 v8, v8, v194, v195
    v_or3_b32 v9, v9, v196, v197
    v_or3_b32 v8, v8, v198, v199
    v_or3_b32 v9, v9, v200, v201
    v_or3_b32 v8, v8, v202, v203
    v_or_b32 v9, v9, v8
    v_and_b32 v9, 2, v9
    v_cmp_ne_u32 vcc, 0, v9
    s_cbranch_vccz L_e3_ok
    s_sub_u32 s62, s62, 1
    s_cbranch_scc0 L_e3
L_e3_ok:
    v_pk_add_f32 v[176:177], v[176:177], v[180:181]
    v_pk_add_f32 v[178:179], v[178:179], v[182:183]
    v_pk_add_f32 v[184:185], v[184:185], v[188:189]
    v_pk_add_f32 v[186:187], v[186:187], v[190:191]
    v_pk_add_f32 v[192:193], v[192:193], v[196:197]
    v_pk_add_f32 v[194:195], v[194:195], v[198:199]
    v_pk_add_f32 v[176:177], v[176:177], v[184:185]
    v_pk_add_f32 v[178:179], v[178:179], v[186:187]
    v_pk_add_f32 v[192:193], v[192:193], v[200:201]
    v_pk_add_f32 v[194:195], v[194:195], v[202:203]
    v_pk_add_f32 v[176:177], v[176:177], v[192:193]
    v_pk_add_f32 v[178:179], v[178:179], v[194:195]
    s_nop 1
    v_permlane32_swap_b32 v176, v178
    v_permlane32_swap_b32 v177, v179
    v_add_f32 v176, v176, v178
    v_add_f32 v177, v177, v179
    s_nop 1
    v_permlane16_swap_b32 v176, v177
    v_add_f32 v176, v176, v177
    s_nop 1
    v_add_f32 v16, v176, v176 row_ror:8 row_mask:0xf bank_mask:0xf
    v_cvt_pk_bf16_f32 v16, v16, v16
    v_and_b32 v16, s94, v16
    v_add_f32 v14, v14, v16
    v_cvt_pk_bf16_f32 v14, v14, v14
    v_and_b32 v14, s94, v14
    v_mov_b32 v16, v14
    v_mov_b32 v17, v14
    s_nop 1
    v_permlane16_swap_b32 v16, v17
    v_perm_b32 v16, v17, v16, s56
    buffer_store_dword v16, v13, s[40:43], s97 offen
L_fin:
L_end:
    s_endpgm
.section .rodata,"a"
.p2align 6
.amdhsa_kernel sequential_preLN__gqa_block_cached__glu_gated_geglu__decode_kernel
  .amdhsa_next_free_vgpr 256
  .amdhsa_next_free_sgpr 102
  .amdhsa_accum_offset 256
  .amdhsa_group_segment_fixed_size 0
  .amdhsa_kernarg_size 96
  .amdhsa_user_sgpr_count 2
  .amdhsa_user_sgpr_kernarg_segment_ptr 1
  .amdhsa_system_sgpr_workgroup_id_x 1
.end_amdhsa_kernel
```
